```python
import torch

def _softmax(x, axis=-1):
    return torch.softmax(x, dim=axis)
def _gelu(x):
    return torch.nn.functional.gelu(x, approximate="tanh")
def _silu(x):
    return torch.nn.functional.silu(x)
def _sigmoid(x):
    return torch.sigmoid(x)
def _layernorm(x, axis=-1, eps=1e-5):
    m = x.mean(dim=axis, keepdim=True)
    v = x.var(dim=axis, keepdim=True, unbiased=False)
    return (x - m) / torch.sqrt(v + eps)
def _scatter_add(tgt, idx, src, axis=0):
    return tgt.clone().index_add_(axis, idx, src)
def _segment_sum(src, seg, n):
    out = torch.zeros((n,) + src.shape[1:], dtype=src.dtype)
    return out.index_add_(0, seg, src)
def _pad(x, pw):
    flat = tuple(v for pair in reversed(pw) for v in pair)
    return torch.nn.functional.pad(x, flat)

kernel_name = 'standalone__groupnorm__sampling'

def setup_inputs():

    _w = (lambda a: (lambda t: t.to(torch.bfloat16) if t.is_floating_point() else t)(torch.as_tensor(a)))
    B = 32
    G = 32
    cpg = max(1, 1024 // G)
    C = G * cpg
    H, W = 32, 32
    return {
        "x": _w(abs((lambda *s: torch.randn(*s, dtype=torch.bfloat16) * 0.05)(B, C, H, W))),
        "g": _w((lambda *s: torch.randn(*s, dtype=torch.bfloat16) * 0.05)(C) + 1.0),
        "b": _w((lambda *s: torch.randn(*s, dtype=torch.bfloat16) * 0.4)(C)),
    }

def reference(x, g, b):
    G = 32
    B, C, H, W = x.shape[0], x.shape[1], x.shape[2], x.shape[3]
    xr = x.reshape(B, G, C // G, H, W)
    mu = xr.mean(axis=(2, 3, 4), keepdims=True)
    var = ((xr - mu) ** 2).mean(axis=(2, 3, 4), keepdims=True)
    xn = (xr - mu) / torch.sqrt(var + 1e-5)
    xn = xn.reshape(B, C, H, W)
    return xn * g[None, :, None, None] + b[None, :, None, None]
```

```asm
; @launch grid=(256,1,1) block=(640,1,1) lds=2304
.amdgcn_target "amdgcn-amd-amdhsa--gfx950"
.text
.globl standalone__groupnorm__sampling_kernel
.p2align 8
.type standalone__groupnorm__sampling_kernel,@function
standalone__groupnorm__sampling_kernel:
    s_load_dwordx8 s[4:11], s[0:1], 0
    s_load_dwordx4 s[44:47], s[0:1], 32
    s_memrealtime s[56:57]
    v_lshrrev_b32 v3, 6, v0
    s_cmpk_ge_u32 s2, 256
    s_cbranch_scc1 L_end
    v_readfirstlane_b32 s3, v3
    s_lshr_b32 s43, s2, 5
    s_xor_b32 s42, s3, 9
    s_or_b32 s42, s42, s43
    s_cbranch_scc1 L_novote
    s_mul_i32 s42, s2, 0x8200
    s_bitset1_b32 s42, 24
    s_xor_b32 s43, s42, 0x2000
    s_bitcmp1_b32 s2, 3
    s_waitcnt lgkmcnt(0)
    s_cselect_b64 s[36:37], s[4:5], s[10:11]
    s_load_dword s40, s[36:37], s42 glc
    s_load_dwordx2 s[52:53], s[36:37], s43 glc
    s_load_dwordx2 s[48:49], s[44:45], 0x80
    s_waitcnt lgkmcnt(4)
    s_getreg_b32 s55, hwreg(HW_REG_IB_STS, 9, 3)
    s_branch L_voted
L_novote:
    v_and_b32 v1, 63, v0
    v_lshlrev_b32 v1, 4, v1
    s_lshr_b32 s27, s2, 3
    s_add_u32 s26, s27, s2
    s_and_b32 s26, s26, 3
    s_lshl2_add_u32 s26, s27, s26
    s_cmp_ge_u32 s3, 8
    s_cbranch_scc1 L_helper
    s_and_b32 s34, s2, 4
    s_lshl_b32 s34, s34, 5
    s_or_b32 s34, s34, s26
    s_lshl3_add_u32 s34, s34, s3
    s_lshl_b32 s70, s34, 13
    s_brev_b32 s14, 32
    s_lshl_b32 s15, 1, 17
    s_waitcnt lgkmcnt(0)
    s_mov_b64 s[12:13], s[4:5]
    buffer_load_dwordx4 v[16:19], v1, s[12:15], s70 offen offset:0 nt
    buffer_load_dwordx4 v[20:23], v1, s[12:15], s70 offen offset:1024 nt
    buffer_load_dwordx4 v[24:27], v1, s[12:15], s70 offen offset:2048 nt
    buffer_load_dwordx4 v[28:31], v1, s[12:15], s70 offen offset:3072 nt
    s_setprio 1
    s_add_u32 s71, s70, 0x1000
    buffer_load_dwordx4 v[32:35], v1, s[12:15], s71 offen offset:0 nt
    buffer_load_dwordx4 v[36:39], v1, s[12:15], s71 offen offset:1024 nt
    buffer_load_dwordx4 v[40:43], v1, s[12:15], s71 offen offset:2048 nt
    buffer_load_dwordx4 v[44:47], v1, s[12:15], s71 offen offset:3072 nt
    s_branch L_worker2
L_voted:
    s_getreg_b32 s39, hwreg(HW_REG_XCC_ID)
    s_add_u32 s59, s36, s42
    s_lshr_b32 s60, s59, 8
    s_xor_b32 s59, s59, s60
    s_lshr_b32 s59, s59, 11
    s_xor_b32 s59, s59, s39
    s_lshr_b32 s59, s59, 1
    s_xnor_b32 s59, s55, s59
    s_and_b32 s59, s59, 2
    s_sub_u32 s60, s39, s2
    s_and_b32 s60, s60, 7
    s_and_b32 s61, s2, 8
    s_lshl_b32 s61, s61, 1
    s_lshr_b64 s[56:57], s[56:57], s61
    s_lshl3_add_u32 s60, s56, s60
    s_lshl2_add_u32 s60, s60, s59
    s_or_b32 s60, s60, 1
    s_lshl_b32 s58, s2, 1
    s_lshr_b32 s58, 0x49244924, s58
    s_and_b32 s58, s58, 3
    s_and_b32 s61, s2, 8
    s_lshl1_add_u32 s58, s58, s61
    s_lshl_b32 s58, s58, 1
    s_mov_b32 s61, 0
    s_cmp_eq_u32 s55, 2
    s_cbranch_scc0 L_weak
    s_atomic_cmpswap s[60:61], s[44:45], s58
    s_barrier
    s_branch L_hvoter
L_worker2:
    s_lshr_b32 s38, s3, 1
    s_and_b32 s31, s3, 1
    s_lshl2_add_u32 s38, s26, s38
    s_lshl_b32 s38, s38, 14
    s_bfe_u32 s34, s38, 0xb000a
    s_load_dwordx4 s[52:55], s[6:7], s34
    s_load_dwordx4 s[56:59], s[8:9], s34
    s_mov_b32 s16, s10
    s_mov_b32 s17, s11
    s_mov_b32 s18, 0x4000000
    s_mov_b32 s19, 0x20000
    s_mov_b32 s25, 0xffff0000
    s_mov_b32 s32, 0x3f803f80
    v_lshrrev_b32 v2, 1, v0
    v_and_b32 v2, 0xf0, v2
    v_mov_b32 v14, 0
    v_mov_b32 v15, 1
    s_barrier
    s_lshl_b32 s34, s2, 12
    s_xor_b32 s34, s34, s38
    s_bfe_u32 s34, s34, 0x1000e
    s_lshl1_add_u32 s34, s34, s31
    s_lshl_b32 s34, s34, 12
    s_add_u32 s34, s34, s38
    s_add_u32 s72, s34, 0x1000000
    buffer_load_dwordx4 v[48:51], v1, s[12:15], s72 offen offset:0 nt
    buffer_load_dwordx4 v[52:55], v1, s[12:15], s72 offen offset:1024 nt
    buffer_load_dwordx4 v[56:59], v1, s[12:15], s72 offen offset:2048 nt
    buffer_load_dwordx4 v[60:63], v1, s[12:15], s72 offen offset:3072 nt
    v_mov_b32 v12, 0
    v_mov_b32 v13, 0
    s_waitcnt vmcnt(11)
    v_dot2c_f32_bf16 v12, s32, v16
    v_dot2c_f32_bf16 v13, v16, v16
    v_dot2c_f32_bf16 v12, s32, v17
    v_dot2c_f32_bf16 v13, v17, v17
    v_dot2c_f32_bf16 v12, s32, v18
    v_dot2c_f32_bf16 v13, v18, v18
    v_dot2c_f32_bf16 v12, s32, v19
    v_dot2c_f32_bf16 v13, v19, v19
    s_waitcnt vmcnt(10)
    v_dot2c_f32_bf16 v12, s32, v20
    v_dot2c_f32_bf16 v13, v20, v20
    v_dot2c_f32_bf16 v12, s32, v21
    v_dot2c_f32_bf16 v13, v21, v21
    v_dot2c_f32_bf16 v12, s32, v22
    v_dot2c_f32_bf16 v13, v22, v22
    v_dot2c_f32_bf16 v12, s32, v23
    v_dot2c_f32_bf16 v13, v23, v23
    s_waitcnt vmcnt(9)
    v_dot2c_f32_bf16 v12, s32, v24
    v_dot2c_f32_bf16 v13, v24, v24
    v_dot2c_f32_bf16 v12, s32, v25
    v_dot2c_f32_bf16 v13, v25, v25
    v_dot2c_f32_bf16 v12, s32, v26
    v_dot2c_f32_bf16 v13, v26, v26
    v_dot2c_f32_bf16 v12, s32, v27
    v_dot2c_f32_bf16 v13, v27, v27
    s_waitcnt vmcnt(8)
    v_dot2c_f32_bf16 v12, s32, v28
    v_dot2c_f32_bf16 v13, v28, v28
    v_dot2c_f32_bf16 v12, s32, v29
    v_dot2c_f32_bf16 v13, v29, v29
    v_dot2c_f32_bf16 v12, s32, v30
    v_dot2c_f32_bf16 v13, v30, v30
    v_dot2c_f32_bf16 v12, s32, v31
    v_dot2c_f32_bf16 v13, v31, v31
    v_readfirstlane_b32 s34, v16
    s_lshl_b32 s35, s34, 16
    v_mov_b32 v10, s35
    v_fmamk_f32 v8, v10, 0xc2000000, v12
    v_add_f32 v9, v12, v8
    v_fma_f32 v9, -v10, v9, v13
    s_nop 1
    v_add_f32_dpp v8, v8, v8 row_ror:8 row_mask:0xf bank_mask:0xf
    v_add_f32_dpp v9, v9, v9 row_ror:8 row_mask:0xf bank_mask:0xf
    s_nop 1
    v_add_f32_dpp v8, v8, v8 row_ror:4 row_mask:0xf bank_mask:0xf
    v_add_f32_dpp v9, v9, v9 row_ror:4 row_mask:0xf bank_mask:0xf
    s_nop 1
    v_add_f32_dpp v8, v8, v8 row_ror:2 row_mask:0xf bank_mask:0xf
    v_add_f32_dpp v9, v9, v9 row_ror:2 row_mask:0xf bank_mask:0xf
    s_nop 1
    v_add_f32_dpp v8, v8, v8 row_ror:1 row_mask:0xf bank_mask:0xf
    v_add_f32_dpp v9, v9, v9 row_ror:1 row_mask:0xf bank_mask:0xf
    s_nop 1
    v_add_f32_dpp v8, v8, v8 row_bcast:15 row_mask:0xa bank_mask:0xf
    v_add_f32_dpp v9, v9, v9 row_bcast:15 row_mask:0xa bank_mask:0xf
    s_mov_b32 exec_lo, s25
    s_mov_b32 exec_hi, s25
    ds_write_b96 v2, v[8:10] offset:0
    s_mov_b64 exec, 1
    ds_add_u32 v14, v15 offset:2176
    s_mov_b64 exec, -1
    s_mov_b64 exec, 1
    ds_add_u32 v14, v15 offset:2236
    s_mov_b64 exec, -1
L_sel:
    ds_read_b32 v4, v14 offset:2240
    s_waitcnt lgkmcnt(0)
    v_readfirstlane_b32 s33, v4
    s_bitcmp1_b32 s33, 2
    s_cbranch_scc1 L_sel2
    s_sleep 1
    s_branch L_sel
L_sel2:
    s_add_u32 s36, s38, s4
    s_lshr_b32 s36, s36, 20
    s_xor_b32 s36, s36, s33
    s_bfe_u32 s36, s36, 0x10001
    s_lshl_b32 s36, s36, 13
    s_sub_u32 s36, s36, s4
    s_add_u32 s37, s36, 0x1000
    s_and_b32 s36, s36, 0x3000
    s_and_b32 s37, s37, 0x3000
    s_add_u32 s36, s38, s36
    s_add_u32 s37, s38, s37
    s_add_u32 s34, s36, s10
    s_lshr_b32 s39, s34, 8
    s_xor_b32 s34, s34, s39
    s_lshr_b32 s34, s34, 13
    s_xor_b32 s34, s34, s33
    s_bitcmp1_b32 s34, 0
    s_cselect_b32 s40, s37, s36
    s_cselect_b32 s41, s36, s37
    s_cmp_eq_u32 s31, 0
    s_cselect_b32 s36, s40, s41
    s_cselect_b32 s37, s41, s40
    s_add_u32 s74, s36, 0x2000000
    s_add_u32 s75, s36, 0x2800000
    s_add_u32 s77, s36, 0x3800000
    s_add_u32 s36, s38, s10
    s_lshr_b32 s36, s36, 21
    s_xor_b32 s36, s36, s33
    s_bfe_u32 s36, s36, 0x10000
    s_lshl_b32 s36, s36, 13
    s_sub_u32 s36, s36, s10
    s_add_u32 s37, s36, 0x1000
    s_and_b32 s36, s36, 0x3000
    s_and_b32 s37, s37, 0x3000
    s_add_u32 s36, s38, s36
    s_add_u32 s37, s38, s37
    s_add_u32 s34, s36, s4
    s_lshr_b32 s39, s34, 8
    s_xor_b32 s34, s34, s39
    s_lshr_b32 s34, s34, 12
    s_xor_b32 s34, s34, s33
    s_bitcmp1_b32 s34, 1
    s_cselect_b32 s42, s37, s36
    s_cselect_b32 s43, s36, s37
    s_cmp_eq_u32 s31, 0
    s_cselect_b32 s36, s42, s43
    s_cselect_b32 s37, s43, s42
    s_add_u32 s73, s36, 0x1800000
    s_add_u32 s76, s36, 0x3000000
    buffer_load_dwordx4 v[64:67], v1, s[12:15], s73 offen offset:0 nt
    buffer_load_dwordx4 v[68:71], v1, s[12:15], s73 offen offset:1024 nt
    buffer_load_dwordx4 v[72:75], v1, s[12:15], s73 offen offset:2048 nt
    buffer_load_dwordx4 v[76:79], v1, s[12:15], s73 offen offset:3072 nt
    v_mov_b32 v12, 0
    v_mov_b32 v13, 0
    s_waitcnt vmcnt(11)
    v_dot2c_f32_bf16 v12, s32, v32
    v_dot2c_f32_bf16 v13, v32, v32
    v_dot2c_f32_bf16 v12, s32, v33
    v_dot2c_f32_bf16 v13, v33, v33
    v_dot2c_f32_bf16 v12, s32, v34
    v_dot2c_f32_bf16 v13, v34, v34
    v_dot2c_f32_bf16 v12, s32, v35
    v_dot2c_f32_bf16 v13, v35, v35
    s_waitcnt vmcnt(10)
    v_dot2c_f32_bf16 v12, s32, v36
    v_dot2c_f32_bf16 v13, v36, v36
    v_dot2c_f32_bf16 v12, s32, v37
    v_dot2c_f32_bf16 v13, v37, v37
    v_dot2c_f32_bf16 v12, s32, v38
    v_dot2c_f32_bf16 v13, v38, v38
    v_dot2c_f32_bf16 v12, s32, v39
    v_dot2c_f32_bf16 v13, v39, v39
    s_waitcnt vmcnt(9)
    v_dot2c_f32_bf16 v12, s32, v40
    v_dot2c_f32_bf16 v13, v40, v40
    v_dot2c_f32_bf16 v12, s32, v41
    v_dot2c_f32_bf16 v13, v41, v41
    v_dot2c_f32_bf16 v12, s32, v42
    v_dot2c_f32_bf16 v13, v42, v42
    v_dot2c_f32_bf16 v12, s32, v43
    v_dot2c_f32_bf16 v13, v43, v43
    s_waitcnt vmcnt(8)
    v_dot2c_f32_bf16 v12, s32, v44
    v_dot2c_f32_bf16 v13, v44, v44
    v_dot2c_f32_bf16 v12, s32, v45
    v_dot2c_f32_bf16 v13, v45, v45
    v_dot2c_f32_bf16 v12, s32, v46
    v_dot2c_f32_bf16 v13, v46, v46
    v_dot2c_f32_bf16 v12, s32, v47
    v_dot2c_f32_bf16 v13, v47, v47
    v_readfirstlane_b32 s34, v32
    s_lshl_b32 s35, s34, 16
    v_mov_b32 v10, s35
    v_fmamk_f32 v8, v10, 0xc2000000, v12
    v_add_f32 v9, v12, v8
    v_fma_f32 v9, -v10, v9, v13
    s_nop 1
    v_add_f32_dpp v8, v8, v8 row_ror:8 row_mask:0xf bank_mask:0xf
    v_add_f32_dpp v9, v9, v9 row_ror:8 row_mask:0xf bank_mask:0xf
    s_nop 1
    v_add_f32_dpp v8, v8, v8 row_ror:4 row_mask:0xf bank_mask:0xf
    v_add_f32_dpp v9, v9, v9 row_ror:4 row_mask:0xf bank_mask:0xf
    s_nop 1
    v_add_f32_dpp v8, v8, v8 row_ror:2 row_mask:0xf bank_mask:0xf
    v_add_f32_dpp v9, v9, v9 row_ror:2 row_mask:0xf bank_mask:0xf
    s_nop 1
    v_add_f32_dpp v8, v8, v8 row_ror:1 row_mask:0xf bank_mask:0xf
    v_add_f32_dpp v9, v9, v9 row_ror:1 row_mask:0xf bank_mask:0xf
    s_nop 1
    v_add_f32_dpp v8, v8, v8 row_bcast:15 row_mask:0xa bank_mask:0xf
    v_add_f32_dpp v9, v9, v9 row_bcast:15 row_mask:0xa bank_mask:0xf
    s_mov_b32 exec_lo, s25
    s_mov_b32 exec_hi, s25
    ds_write_b96 v2, v[8:10] offset:256
    s_mov_b64 exec, 1
    ds_add_u32 v14, v15 offset:2180
    s_mov_b64 exec, -1
L_fin0:
    ds_read_b96 v[8:10], v14 offset:2048
    s_waitcnt lgkmcnt(0)
    v_cmp_ne_u32 vcc, 1, v10
    s_cbranch_vccz L_go0
    v_cmp_eq_u32 vcc, 0, v10
    s_cbranch_vccz L_pre0
    s_sleep 1
    s_branch L_fin0
L_go0:
    s_bfe_u32 m0, s70, 0x2000c
    s_nop 0
    s_movrels_b32 s84, s52
    s_movrels_b32 s86, s56
    s_lshl_b32 s34, s84, 16
    s_lshl_b32 s35, s86, 16
    v_mul_f32 v12, s34, v9
    v_fma_f32 v13, -v8, v12, s35
    v_lshlrev_b32 v4, 16, v16
    v_and_b32 v5, s25, v16
    v_pk_fma_f32 v[4:5], v[4:5], v[12:13], v[12:13] op_sel:[0,0,1] op_sel_hi:[1,0,1]
    v_cvt_pk_bf16_f32 v16, v4, v5
    v_lshlrev_b32 v6, 16, v17
    v_and_b32 v7, s25, v17
    v_pk_fma_f32 v[6:7], v[6:7], v[12:13], v[12:13] op_sel:[0,0,1] op_sel_hi:[1,0,1]
    v_cvt_pk_bf16_f32 v17, v6, v7
    v_lshlrev_b32 v4, 16, v18
    v_and_b32 v5, s25, v18
    v_pk_fma_f32 v[4:5], v[4:5], v[12:13], v[12:13] op_sel:[0,0,1] op_sel_hi:[1,0,1]
    v_cvt_pk_bf16_f32 v18, v4, v5
    v_lshlrev_b32 v6, 16, v19
    v_and_b32 v7, s25, v19
    v_pk_fma_f32 v[6:7], v[6:7], v[12:13], v[12:13] op_sel:[0,0,1] op_sel_hi:[1,0,1]
    v_cvt_pk_bf16_f32 v19, v6, v7
    v_lshlrev_b32 v4, 16, v20
    v_and_b32 v5, s25, v20
    v_pk_fma_f32 v[4:5], v[4:5], v[12:13], v[12:13] op_sel:[0,0,1] op_sel_hi:[1,0,1]
    v_cvt_pk_bf16_f32 v20, v4, v5
    v_lshlrev_b32 v6, 16, v21
    v_and_b32 v7, s25, v21
    v_pk_fma_f32 v[6:7], v[6:7], v[12:13], v[12:13] op_sel:[0,0,1] op_sel_hi:[1,0,1]
    v_cvt_pk_bf16_f32 v21, v6, v7
    v_lshlrev_b32 v4, 16, v22
    v_and_b32 v5, s25, v22
    v_pk_fma_f32 v[4:5], v[4:5], v[12:13], v[12:13] op_sel:[0,0,1] op_sel_hi:[1,0,1]
    v_cvt_pk_bf16_f32 v22, v4, v5
    v_lshlrev_b32 v6, 16, v23
    v_and_b32 v7, s25, v23
    v_pk_fma_f32 v[6:7], v[6:7], v[12:13], v[12:13] op_sel:[0,0,1] op_sel_hi:[1,0,1]
    v_cvt_pk_bf16_f32 v23, v6, v7
    s_and_b32 s34, s84, s25
    s_and_b32 s35, s86, s25
    v_mul_f32 v12, s34, v9
    v_fma_f32 v13, -v8, v12, s35
    v_lshlrev_b32 v4, 16, v24
    v_and_b32 v5, s25, v24
    v_pk_fma_f32 v[4:5], v[4:5], v[12:13], v[12:13] op_sel:[0,0,1] op_sel_hi:[1,0,1]
    v_cvt_pk_bf16_f32 v24, v4, v5
    v_lshlrev_b32 v6, 16, v25
    v_and_b32 v7, s25, v25
    v_pk_fma_f32 v[6:7], v[6:7], v[12:13], v[12:13] op_sel:[0,0,1] op_sel_hi:[1,0,1]
    v_cvt_pk_bf16_f32 v25, v6, v7
    v_lshlrev_b32 v4, 16, v26
    v_and_b32 v5, s25, v26
    v_pk_fma_f32 v[4:5], v[4:5], v[12:13], v[12:13] op_sel:[0,0,1] op_sel_hi:[1,0,1]
    v_cvt_pk_bf16_f32 v26, v4, v5
    v_lshlrev_b32 v6, 16, v27
    v_and_b32 v7, s25, v27
    v_pk_fma_f32 v[6:7], v[6:7], v[12:13], v[12:13] op_sel:[0,0,1] op_sel_hi:[1,0,1]
    v_cvt_pk_bf16_f32 v27, v6, v7
    v_lshlrev_b32 v4, 16, v28
    v_and_b32 v5, s25, v28
    v_pk_fma_f32 v[4:5], v[4:5], v[12:13], v[12:13] op_sel:[0,0,1] op_sel_hi:[1,0,1]
    v_cvt_pk_bf16_f32 v28, v4, v5
    v_lshlrev_b32 v6, 16, v29
    v_and_b32 v7, s25, v29
    v_pk_fma_f32 v[6:7], v[6:7], v[12:13], v[12:13] op_sel:[0,0,1] op_sel_hi:[1,0,1]
    v_cvt_pk_bf16_f32 v29, v6, v7
    v_lshlrev_b32 v4, 16, v30
    v_and_b32 v5, s25, v30
    v_pk_fma_f32 v[4:5], v[4:5], v[12:13], v[12:13] op_sel:[0,0,1] op_sel_hi:[1,0,1]
    v_cvt_pk_bf16_f32 v30, v4, v5
    v_lshlrev_b32 v6, 16, v31
    v_and_b32 v7, s25, v31
    v_pk_fma_f32 v[6:7], v[6:7], v[12:13], v[12:13] op_sel:[0,0,1] op_sel_hi:[1,0,1]
    v_cvt_pk_bf16_f32 v31, v6, v7
    buffer_load_dwordx4 v[80:83], v1, s[12:15], s74 offen offset:0 nt
    buffer_load_dwordx4 v[84:87], v1, s[12:15], s74 offen offset:1024 nt
    buffer_load_dwordx4 v[88:91], v1, s[12:15], s74 offen offset:2048 nt
    buffer_load_dwordx4 v[92:95], v1, s[12:15], s74 offen offset:3072 nt
    buffer_store_dwordx4 v[16:19], v1, s[16:19], s70 offen offset:0 sc1
    buffer_store_dwordx4 v[20:23], v1, s[16:19], s70 offen offset:1024 sc1
    buffer_store_dwordx4 v[24:27], v1, s[16:19], s70 offen offset:2048 sc1
    buffer_store_dwordx4 v[28:31], v1, s[16:19], s70 offen offset:3072 sc1
    v_mov_b32 v12, 0
    v_mov_b32 v13, 0
    s_waitcnt vmcnt(15)
    v_dot2c_f32_bf16 v12, s32, v48
    v_dot2c_f32_bf16 v13, v48, v48
    v_dot2c_f32_bf16 v12, s32, v49
    v_dot2c_f32_bf16 v13, v49, v49
    v_dot2c_f32_bf16 v12, s32, v50
    v_dot2c_f32_bf16 v13, v50, v50
    v_dot2c_f32_bf16 v12, s32, v51
    v_dot2c_f32_bf16 v13, v51, v51
    s_waitcnt vmcnt(14)
    v_dot2c_f32_bf16 v12, s32, v52
    v_dot2c_f32_bf16 v13, v52, v52
    v_dot2c_f32_bf16 v12, s32, v53
    v_dot2c_f32_bf16 v13, v53, v53
    v_dot2c_f32_bf16 v12, s32, v54
    v_dot2c_f32_bf16 v13, v54, v54
    v_dot2c_f32_bf16 v12, s32, v55
    v_dot2c_f32_bf16 v13, v55, v55
    s_waitcnt vmcnt(13)
    v_dot2c_f32_bf16 v12, s32, v56
    v_dot2c_f32_bf16 v13, v56, v56
    v_dot2c_f32_bf16 v12, s32, v57
    v_dot2c_f32_bf16 v13, v57, v57
    v_dot2c_f32_bf16 v12, s32, v58
    v_dot2c_f32_bf16 v13, v58, v58
    v_dot2c_f32_bf16 v12, s32, v59
    v_dot2c_f32_bf16 v13, v59, v59
    s_waitcnt vmcnt(12)
    v_dot2c_f32_bf16 v12, s32, v60
    v_dot2c_f32_bf16 v13, v60, v60
    v_dot2c_f32_bf16 v12, s32, v61
    v_dot2c_f32_bf16 v13, v61, v61
    v_dot2c_f32_bf16 v12, s32, v62
    v_dot2c_f32_bf16 v13, v62, v62
    v_dot2c_f32_bf16 v12, s32, v63
    v_dot2c_f32_bf16 v13, v63, v63
    v_readfirstlane_b32 s34, v48
    s_lshl_b32 s35, s34, 16
    v_mov_b32 v10, s35
    v_fmamk_f32 v8, v10, 0xc2000000, v12
    v_add_f32 v9, v12, v8
    v_fma_f32 v9, -v10, v9, v13
    s_nop 1
    v_add_f32_dpp v8, v8, v8 row_ror:8 row_mask:0xf bank_mask:0xf
    v_add_f32_dpp v9, v9, v9 row_ror:8 row_mask:0xf bank_mask:0xf
    s_nop 1
    v_add_f32_dpp v8, v8, v8 row_ror:4 row_mask:0xf bank_mask:0xf
    v_add_f32_dpp v9, v9, v9 row_ror:4 row_mask:0xf bank_mask:0xf
    s_nop 1
    v_add_f32_dpp v8, v8, v8 row_ror:2 row_mask:0xf bank_mask:0xf
    v_add_f32_dpp v9, v9, v9 row_ror:2 row_mask:0xf bank_mask:0xf
    s_nop 1
    v_add_f32_dpp v8, v8, v8 row_ror:1 row_mask:0xf bank_mask:0xf
    v_add_f32_dpp v9, v9, v9 row_ror:1 row_mask:0xf bank_mask:0xf
    s_nop 1
    v_add_f32_dpp v8, v8, v8 row_bcast:15 row_mask:0xa bank_mask:0xf
    v_add_f32_dpp v9, v9, v9 row_bcast:15 row_mask:0xa bank_mask:0xf
    s_mov_b32 exec_lo, s25
    s_mov_b32 exec_hi, s25
    ds_write_b96 v2, v[8:10] offset:512
    s_mov_b64 exec, 1
    ds_add_u32 v14, v15 offset:2184
    s_mov_b64 exec, -1
    v_mov_b32 v12, 0
    v_mov_b32 v13, 0
    s_waitcnt vmcnt(11)
    v_dot2c_f32_bf16 v12, s32, v64
    v_dot2c_f32_bf16 v13, v64, v64
    v_dot2c_f32_bf16 v12, s32, v65
    v_dot2c_f32_bf16 v13, v65, v65
    v_dot2c_f32_bf16 v12, s32, v66
    v_dot2c_f32_bf16 v13, v66, v66
    v_dot2c_f32_bf16 v12, s32, v67
    v_dot2c_f32_bf16 v13, v67, v67
    s_waitcnt vmcnt(10)
    v_dot2c_f32_bf16 v12, s32, v68
    v_dot2c_f32_bf16 v13, v68, v68
    v_dot2c_f32_bf16 v12, s32, v69
    v_dot2c_f32_bf16 v13, v69, v69
    v_dot2c_f32_bf16 v12, s32, v70
    v_dot2c_f32_bf16 v13, v70, v70
    v_dot2c_f32_bf16 v12, s32, v71
    v_dot2c_f32_bf16 v13, v71, v71
    s_waitcnt vmcnt(9)
    v_dot2c_f32_bf16 v12, s32, v72
    v_dot2c_f32_bf16 v13, v72, v72
    v_dot2c_f32_bf16 v12, s32, v73
    v_dot2c_f32_bf16 v13, v73, v73
    v_dot2c_f32_bf16 v12, s32, v74
    v_dot2c_f32_bf16 v13, v74, v74
    v_dot2c_f32_bf16 v12, s32, v75
    v_dot2c_f32_bf16 v13, v75, v75
    s_waitcnt vmcnt(8)
    v_dot2c_f32_bf16 v12, s32, v76
    v_dot2c_f32_bf16 v13, v76, v76
    v_dot2c_f32_bf16 v12, s32, v77
    v_dot2c_f32_bf16 v13, v77, v77
    v_dot2c_f32_bf16 v12, s32, v78
    v_dot2c_f32_bf16 v13, v78, v78
    v_dot2c_f32_bf16 v12, s32, v79
    v_dot2c_f32_bf16 v13, v79, v79
    v_readfirstlane_b32 s34, v64
    s_lshl_b32 s35, s34, 16
    v_mov_b32 v10, s35
    v_fmamk_f32 v8, v10, 0xc2000000, v12
    v_add_f32 v9, v12, v8
    v_fma_f32 v9, -v10, v9, v13
    s_nop 1
    v_add_f32_dpp v8, v8, v8 row_ror:8 row_mask:0xf bank_mask:0xf
    v_add_f32_dpp v9, v9, v9 row_ror:8 row_mask:0xf bank_mask:0xf
    s_nop 1
    v_add_f32_dpp v8, v8, v8 row_ror:4 row_mask:0xf bank_mask:0xf
    v_add_f32_dpp v9, v9, v9 row_ror:4 row_mask:0xf bank_mask:0xf
    s_nop 1
    v_add_f32_dpp v8, v8, v8 row_ror:2 row_mask:0xf bank_mask:0xf
    v_add_f32_dpp v9, v9, v9 row_ror:2 row_mask:0xf bank_mask:0xf
    s_nop 1
    v_add_f32_dpp v8, v8, v8 row_ror:1 row_mask:0xf bank_mask:0xf
    v_add_f32_dpp v9, v9, v9 row_ror:1 row_mask:0xf bank_mask:0xf
    s_nop 1
    v_add_f32_dpp v8, v8, v8 row_bcast:15 row_mask:0xa bank_mask:0xf
    v_add_f32_dpp v9, v9, v9 row_bcast:15 row_mask:0xa bank_mask:0xf
    s_mov_b32 exec_lo, s25
    s_mov_b32 exec_hi, s25
    ds_write_b96 v2, v[8:10] offset:768
    s_mov_b64 exec, 1
    ds_add_u32 v14, v15 offset:2188
    s_mov_b64 exec, -1
L_fin1:
    ds_read_b96 v[8:10], v14 offset:2064
    s_waitcnt lgkmcnt(0)
    v_cmp_ne_u32 vcc, 1, v10
    s_cbranch_vccz L_go1
    v_cmp_eq_u32 vcc, 0, v10
    s_cbranch_vccz L_pre1
    s_sleep 1
    s_branch L_fin1
L_go1:
    s_bfe_u32 m0, s71, 0x2000c
    s_nop 0
    s_movrels_b32 s84, s52
    s_movrels_b32 s86, s56
    s_lshl_b32 s34, s84, 16
    s_lshl_b32 s35, s86, 16
    v_mul_f32 v12, s34, v9
    v_fma_f32 v13, -v8, v12, s35
    v_lshlrev_b32 v4, 16, v32
    v_and_b32 v5, s25, v32
    v_pk_fma_f32 v[4:5], v[4:5], v[12:13], v[12:13] op_sel:[0,0,1] op_sel_hi:[1,0,1]
    v_cvt_pk_bf16_f32 v32, v4, v5
    v_lshlrev_b32 v6, 16, v33
    v_and_b32 v7, s25, v33
    v_pk_fma_f32 v[6:7], v[6:7], v[12:13], v[12:13] op_sel:[0,0,1] op_sel_hi:[1,0,1]
    v_cvt_pk_bf16_f32 v33, v6, v7
    v_lshlrev_b32 v4, 16, v34
    v_and_b32 v5, s25, v34
    v_pk_fma_f32 v[4:5], v[4:5], v[12:13], v[12:13] op_sel:[0,0,1] op_sel_hi:[1,0,1]
    v_cvt_pk_bf16_f32 v34, v4, v5
    v_lshlrev_b32 v6, 16, v35
    v_and_b32 v7, s25, v35
    v_pk_fma_f32 v[6:7], v[6:7], v[12:13], v[12:13] op_sel:[0,0,1] op_sel_hi:[1,0,1]
    v_cvt_pk_bf16_f32 v35, v6, v7
    v_lshlrev_b32 v4, 16, v36
    v_and_b32 v5, s25, v36
    v_pk_fma_f32 v[4:5], v[4:5], v[12:13], v[12:13] op_sel:[0,0,1] op_sel_hi:[1,0,1]
    v_cvt_pk_bf16_f32 v36, v4, v5
    v_lshlrev_b32 v6, 16, v37
    v_and_b32 v7, s25, v37
    v_pk_fma_f32 v[6:7], v[6:7], v[12:13], v[12:13] op_sel:[0,0,1] op_sel_hi:[1,0,1]
    v_cvt_pk_bf16_f32 v37, v6, v7
    v_lshlrev_b32 v4, 16, v38
    v_and_b32 v5, s25, v38
    v_pk_fma_f32 v[4:5], v[4:5], v[12:13], v[12:13] op_sel:[0,0,1] op_sel_hi:[1,0,1]
    v_cvt_pk_bf16_f32 v38, v4, v5
    v_lshlrev_b32 v6, 16, v39
    v_and_b32 v7, s25, v39
    v_pk_fma_f32 v[6:7], v[6:7], v[12:13], v[12:13] op_sel:[0,0,1] op_sel_hi:[1,0,1]
    v_cvt_pk_bf16_f32 v39, v6, v7
    s_and_b32 s34, s84, s25
    s_and_b32 s35, s86, s25
    v_mul_f32 v12, s34, v9
    v_fma_f32 v13, -v8, v12, s35
    v_lshlrev_b32 v4, 16, v40
    v_and_b32 v5, s25, v40
    v_pk_fma_f32 v[4:5], v[4:5], v[12:13], v[12:13] op_sel:[0,0,1] op_sel_hi:[1,0,1]
    v_cvt_pk_bf16_f32 v40, v4, v5
    v_lshlrev_b32 v6, 16, v41
    v_and_b32 v7, s25, v41
    v_pk_fma_f32 v[6:7], v[6:7], v[12:13], v[12:13] op_sel:[0,0,1] op_sel_hi:[1,0,1]
    v_cvt_pk_bf16_f32 v41, v6, v7
    v_lshlrev_b32 v4, 16, v42
    v_and_b32 v5, s25, v42
    v_pk_fma_f32 v[4:5], v[4:5], v[12:13], v[12:13] op_sel:[0,0,1] op_sel_hi:[1,0,1]
    v_cvt_pk_bf16_f32 v42, v4, v5
    v_lshlrev_b32 v6, 16, v43
    v_and_b32 v7, s25, v43
    v_pk_fma_f32 v[6:7], v[6:7], v[12:13], v[12:13] op_sel:[0,0,1] op_sel_hi:[1,0,1]
    v_cvt_pk_bf16_f32 v43, v6, v7
    v_lshlrev_b32 v4, 16, v44
    v_and_b32 v5, s25, v44
    v_pk_fma_f32 v[4:5], v[4:5], v[12:13], v[12:13] op_sel:[0,0,1] op_sel_hi:[1,0,1]
    v_cvt_pk_bf16_f32 v44, v4, v5
    v_lshlrev_b32 v6, 16, v45
    v_and_b32 v7, s25, v45
    v_pk_fma_f32 v[6:7], v[6:7], v[12:13], v[12:13] op_sel:[0,0,1] op_sel_hi:[1,0,1]
    v_cvt_pk_bf16_f32 v45, v6, v7
    v_lshlrev_b32 v4, 16, v46
    v_and_b32 v5, s25, v46
    v_pk_fma_f32 v[4:5], v[4:5], v[12:13], v[12:13] op_sel:[0,0,1] op_sel_hi:[1,0,1]
    v_cvt_pk_bf16_f32 v46, v4, v5
    v_lshlrev_b32 v6, 16, v47
    v_and_b32 v7, s25, v47
    v_pk_fma_f32 v[6:7], v[6:7], v[12:13], v[12:13] op_sel:[0,0,1] op_sel_hi:[1,0,1]
    v_cvt_pk_bf16_f32 v47, v6, v7
    buffer_store_dwordx4 v[32:35], v1, s[16:19], s71 offen offset:0 sc1
    buffer_store_dwordx4 v[36:39], v1, s[16:19], s71 offen offset:1024 sc1
    buffer_store_dwordx4 v[40:43], v1, s[16:19], s71 offen offset:2048 sc1
    buffer_store_dwordx4 v[44:47], v1, s[16:19], s71 offen offset:3072 sc1
    buffer_load_dwordx4 v[96:99], v1, s[12:15], s75 offen offset:0 nt
    buffer_load_dwordx4 v[100:103], v1, s[12:15], s75 offen offset:1024 nt
    buffer_load_dwordx4 v[104:107], v1, s[12:15], s75 offen offset:2048 nt
    buffer_load_dwordx4 v[108:111], v1, s[12:15], s75 offen offset:3072 nt
L_fin2:
    ds_read_b96 v[8:10], v14 offset:2080
    s_waitcnt lgkmcnt(0)
    v_cmp_ne_u32 vcc, 1, v10
    s_cbranch_vccz L_go2
    v_cmp_eq_u32 vcc, 0, v10
    s_cbranch_vccz L_pre2
    s_sleep 1
    s_branch L_fin2
L_go2:
    s_bfe_u32 m0, s72, 0x2000c
    s_nop 0
    s_movrels_b32 s84, s52
    s_movrels_b32 s86, s56
    s_lshl_b32 s34, s84, 16
    s_lshl_b32 s35, s86, 16
    v_mul_f32 v12, s34, v9
    v_fma_f32 v13, -v8, v12, s35
    v_lshlrev_b32 v4, 16, v48
    v_and_b32 v5, s25, v48
    v_pk_fma_f32 v[4:5], v[4:5], v[12:13], v[12:13] op_sel:[0,0,1] op_sel_hi:[1,0,1]
    v_cvt_pk_bf16_f32 v48, v4, v5
    v_lshlrev_b32 v6, 16, v49
    v_and_b32 v7, s25, v49
    v_pk_fma_f32 v[6:7], v[6:7], v[12:13], v[12:13] op_sel:[0,0,1] op_sel_hi:[1,0,1]
    v_cvt_pk_bf16_f32 v49, v6, v7
    v_lshlrev_b32 v4, 16, v50
    v_and_b32 v5, s25, v50
    v_pk_fma_f32 v[4:5], v[4:5], v[12:13], v[12:13] op_sel:[0,0,1] op_sel_hi:[1,0,1]
    v_cvt_pk_bf16_f32 v50, v4, v5
    v_lshlrev_b32 v6, 16, v51
    v_and_b32 v7, s25, v51
    v_pk_fma_f32 v[6:7], v[6:7], v[12:13], v[12:13] op_sel:[0,0,1] op_sel_hi:[1,0,1]
    v_cvt_pk_bf16_f32 v51, v6, v7
    v_lshlrev_b32 v4, 16, v52
    v_and_b32 v5, s25, v52
    v_pk_fma_f32 v[4:5], v[4:5], v[12:13], v[12:13] op_sel:[0,0,1] op_sel_hi:[1,0,1]
    v_cvt_pk_bf16_f32 v52, v4, v5
    v_lshlrev_b32 v6, 16, v53
    v_and_b32 v7, s25, v53
    v_pk_fma_f32 v[6:7], v[6:7], v[12:13], v[12:13] op_sel:[0,0,1] op_sel_hi:[1,0,1]
    v_cvt_pk_bf16_f32 v53, v6, v7
    v_lshlrev_b32 v4, 16, v54
    v_and_b32 v5, s25, v54
    v_pk_fma_f32 v[4:5], v[4:5], v[12:13], v[12:13] op_sel:[0,0,1] op_sel_hi:[1,0,1]
    v_cvt_pk_bf16_f32 v54, v4, v5
    v_lshlrev_b32 v6, 16, v55
    v_and_b32 v7, s25, v55
    v_pk_fma_f32 v[6:7], v[6:7], v[12:13], v[12:13] op_sel:[0,0,1] op_sel_hi:[1,0,1]
    v_cvt_pk_bf16_f32 v55, v6, v7
    s_and_b32 s34, s84, s25
    s_and_b32 s35, s86, s25
    v_mul_f32 v12, s34, v9
    v_fma_f32 v13, -v8, v12, s35
    v_lshlrev_b32 v4, 16, v56
    v_and_b32 v5, s25, v56
    v_pk_fma_f32 v[4:5], v[4:5], v[12:13], v[12:13] op_sel:[0,0,1] op_sel_hi:[1,0,1]
    v_cvt_pk_bf16_f32 v56, v4, v5
    v_lshlrev_b32 v6, 16, v57
    v_and_b32 v7, s25, v57
    v_pk_fma_f32 v[6:7], v[6:7], v[12:13], v[12:13] op_sel:[0,0,1] op_sel_hi:[1,0,1]
    v_cvt_pk_bf16_f32 v57, v6, v7
    v_lshlrev_b32 v4, 16, v58
    v_and_b32 v5, s25, v58
    v_pk_fma_f32 v[4:5], v[4:5], v[12:13], v[12:13] op_sel:[0,0,1] op_sel_hi:[1,0,1]
    v_cvt_pk_bf16_f32 v58, v4, v5
    v_lshlrev_b32 v6, 16, v59
    v_and_b32 v7, s25, v59
    v_pk_fma_f32 v[6:7], v[6:7], v[12:13], v[12:13] op_sel:[0,0,1] op_sel_hi:[1,0,1]
    v_cvt_pk_bf16_f32 v59, v6, v7
    v_lshlrev_b32 v4, 16, v60
    v_and_b32 v5, s25, v60
    v_pk_fma_f32 v[4:5], v[4:5], v[12:13], v[12:13] op_sel:[0,0,1] op_sel_hi:[1,0,1]
    v_cvt_pk_bf16_f32 v60, v4, v5
    v_lshlrev_b32 v6, 16, v61
    v_and_b32 v7, s25, v61
    v_pk_fma_f32 v[6:7], v[6:7], v[12:13], v[12:13] op_sel:[0,0,1] op_sel_hi:[1,0,1]
    v_cvt_pk_bf16_f32 v61, v6, v7
    v_lshlrev_b32 v4, 16, v62
    v_and_b32 v5, s25, v62
    v_pk_fma_f32 v[4:5], v[4:5], v[12:13], v[12:13] op_sel:[0,0,1] op_sel_hi:[1,0,1]
    v_cvt_pk_bf16_f32 v62, v4, v5
    v_lshlrev_b32 v6, 16, v63
    v_and_b32 v7, s25, v63
    v_pk_fma_f32 v[6:7], v[6:7], v[12:13], v[12:13] op_sel:[0,0,1] op_sel_hi:[1,0,1]
    v_cvt_pk_bf16_f32 v63, v6, v7
    v_mov_b32 v12, 0
    v_mov_b32 v13, 0
    s_waitcnt vmcnt(3)
    v_dot2c_f32_bf16 v12, s32, v96
    v_dot2c_f32_bf16 v13, v96, v96
    v_dot2c_f32_bf16 v12, s32, v97
    v_dot2c_f32_bf16 v13, v97, v97
    v_dot2c_f32_bf16 v12, s32, v98
    v_dot2c_f32_bf16 v13, v98, v98
    v_dot2c_f32_bf16 v12, s32, v99
    v_dot2c_f32_bf16 v13, v99, v99
    s_waitcnt vmcnt(2)
    v_dot2c_f32_bf16 v12, s32, v100
    v_dot2c_f32_bf16 v13, v100, v100
    v_dot2c_f32_bf16 v12, s32, v101
    v_dot2c_f32_bf16 v13, v101, v101
    v_dot2c_f32_bf16 v12, s32, v102
    v_dot2c_f32_bf16 v13, v102, v102
    v_dot2c_f32_bf16 v12, s32, v103
    v_dot2c_f32_bf16 v13, v103, v103
    s_waitcnt vmcnt(1)
    v_dot2c_f32_bf16 v12, s32, v104
    v_dot2c_f32_bf16 v13, v104, v104
    v_dot2c_f32_bf16 v12, s32, v105
    v_dot2c_f32_bf16 v13, v105, v105
    v_dot2c_f32_bf16 v12, s32, v106
    v_dot2c_f32_bf16 v13, v106, v106
    v_dot2c_f32_bf16 v12, s32, v107
    v_dot2c_f32_bf16 v13, v107, v107
    s_waitcnt vmcnt(0)
    v_dot2c_f32_bf16 v12, s32, v108
    v_dot2c_f32_bf16 v13, v108, v108
    v_dot2c_f32_bf16 v12, s32, v109
    v_dot2c_f32_bf16 v13, v109, v109
    v_dot2c_f32_bf16 v12, s32, v110
    v_dot2c_f32_bf16 v13, v110, v110
    v_dot2c_f32_bf16 v12, s32, v111
    v_dot2c_f32_bf16 v13, v111, v111
    v_readfirstlane_b32 s34, v96
    s_lshl_b32 s35, s34, 16
    v_mov_b32 v10, s35
    v_fmamk_f32 v8, v10, 0xc2000000, v12
    v_add_f32 v9, v12, v8
    v_fma_f32 v9, -v10, v9, v13
    s_nop 1
    v_add_f32_dpp v8, v8, v8 row_ror:8 row_mask:0xf bank_mask:0xf
    v_add_f32_dpp v9, v9, v9 row_ror:8 row_mask:0xf bank_mask:0xf
    s_nop 1
    v_add_f32_dpp v8, v8, v8 row_ror:4 row_mask:0xf bank_mask:0xf
    v_add_f32_dpp v9, v9, v9 row_ror:4 row_mask:0xf bank_mask:0xf
    s_nop 1
    v_add_f32_dpp v8, v8, v8 row_ror:2 row_mask:0xf bank_mask:0xf
    v_add_f32_dpp v9, v9, v9 row_ror:2 row_mask:0xf bank_mask:0xf
    s_nop 1
    v_add_f32_dpp v8, v8, v8 row_ror:1 row_mask:0xf bank_mask:0xf
    v_add_f32_dpp v9, v9, v9 row_ror:1 row_mask:0xf bank_mask:0xf
    s_nop 1
    v_add_f32_dpp v8, v8, v8 row_bcast:15 row_mask:0xa bank_mask:0xf
    v_add_f32_dpp v9, v9, v9 row_bcast:15 row_mask:0xa bank_mask:0xf
    s_mov_b32 exec_lo, s25
    s_mov_b32 exec_hi, s25
    ds_write_b96 v2, v[8:10] offset:1280
    s_mov_b64 exec, 1
    ds_add_u32 v14, v15 offset:2196
    s_mov_b64 exec, -1
    buffer_load_dwordx4 v[112:115], v1, s[12:15], s76 offen offset:0 nt
    buffer_load_dwordx4 v[116:119], v1, s[12:15], s76 offen offset:1024 nt
    buffer_load_dwordx4 v[120:123], v1, s[12:15], s76 offen offset:2048 nt
    buffer_load_dwordx4 v[124:127], v1, s[12:15], s76 offen offset:3072 nt
L_fin3:
    ds_read_b96 v[8:10], v14 offset:2096
    s_waitcnt lgkmcnt(0)
    v_cmp_ne_u32 vcc, 1, v10
    s_cbranch_vccz L_go3
    v_cmp_eq_u32 vcc, 0, v10
    s_cbranch_vccz L_pre3
    s_sleep 1
    s_branch L_fin3
L_go3:
    s_bfe_u32 m0, s73, 0x2000c
    s_nop 0
    s_movrels_b32 s84, s52
    s_movrels_b32 s86, s56
    s_lshl_b32 s34, s84, 16
    s_lshl_b32 s35, s86, 16
    v_mul_f32 v12, s34, v9
    v_fma_f32 v13, -v8, v12, s35
    v_lshlrev_b32 v4, 16, v64
    v_and_b32 v5, s25, v64
    v_pk_fma_f32 v[4:5], v[4:5], v[12:13], v[12:13] op_sel:[0,0,1] op_sel_hi:[1,0,1]
    v_cvt_pk_bf16_f32 v64, v4, v5
    v_lshlrev_b32 v6, 16, v65
    v_and_b32 v7, s25, v65
    v_pk_fma_f32 v[6:7], v[6:7], v[12:13], v[12:13] op_sel:[0,0,1] op_sel_hi:[1,0,1]
    v_cvt_pk_bf16_f32 v65, v6, v7
    v_lshlrev_b32 v4, 16, v66
    v_and_b32 v5, s25, v66
    v_pk_fma_f32 v[4:5], v[4:5], v[12:13], v[12:13] op_sel:[0,0,1] op_sel_hi:[1,0,1]
    v_cvt_pk_bf16_f32 v66, v4, v5
    v_lshlrev_b32 v6, 16, v67
    v_and_b32 v7, s25, v67
    v_pk_fma_f32 v[6:7], v[6:7], v[12:13], v[12:13] op_sel:[0,0,1] op_sel_hi:[1,0,1]
    v_cvt_pk_bf16_f32 v67, v6, v7
    v_lshlrev_b32 v4, 16, v68
    v_and_b32 v5, s25, v68
    v_pk_fma_f32 v[4:5], v[4:5], v[12:13], v[12:13] op_sel:[0,0,1] op_sel_hi:[1,0,1]
    v_cvt_pk_bf16_f32 v68, v4, v5
    v_lshlrev_b32 v6, 16, v69
    v_and_b32 v7, s25, v69
    v_pk_fma_f32 v[6:7], v[6:7], v[12:13], v[12:13] op_sel:[0,0,1] op_sel_hi:[1,0,1]
    v_cvt_pk_bf16_f32 v69, v6, v7
    v_lshlrev_b32 v4, 16, v70
    v_and_b32 v5, s25, v70
    v_pk_fma_f32 v[4:5], v[4:5], v[12:13], v[12:13] op_sel:[0,0,1] op_sel_hi:[1,0,1]
    v_cvt_pk_bf16_f32 v70, v4, v5
    v_lshlrev_b32 v6, 16, v71
    v_and_b32 v7, s25, v71
    v_pk_fma_f32 v[6:7], v[6:7], v[12:13], v[12:13] op_sel:[0,0,1] op_sel_hi:[1,0,1]
    v_cvt_pk_bf16_f32 v71, v6, v7
    s_and_b32 s34, s84, s25
    s_and_b32 s35, s86, s25
    v_mul_f32 v12, s34, v9
    v_fma_f32 v13, -v8, v12, s35
    v_lshlrev_b32 v4, 16, v72
    v_and_b32 v5, s25, v72
    v_pk_fma_f32 v[4:5], v[4:5], v[12:13], v[12:13] op_sel:[0,0,1] op_sel_hi:[1,0,1]
    v_cvt_pk_bf16_f32 v72, v4, v5
    v_lshlrev_b32 v6, 16, v73
    v_and_b32 v7, s25, v73
    v_pk_fma_f32 v[6:7], v[6:7], v[12:13], v[12:13] op_sel:[0,0,1] op_sel_hi:[1,0,1]
    v_cvt_pk_bf16_f32 v73, v6, v7
    v_lshlrev_b32 v4, 16, v74
    v_and_b32 v5, s25, v74
    v_pk_fma_f32 v[4:5], v[4:5], v[12:13], v[12:13] op_sel:[0,0,1] op_sel_hi:[1,0,1]
    v_cvt_pk_bf16_f32 v74, v4, v5
    v_lshlrev_b32 v6, 16, v75
    v_and_b32 v7, s25, v75
    v_pk_fma_f32 v[6:7], v[6:7], v[12:13], v[12:13] op_sel:[0,0,1] op_sel_hi:[1,0,1]
    v_cvt_pk_bf16_f32 v75, v6, v7
    v_lshlrev_b32 v4, 16, v76
    v_and_b32 v5, s25, v76
    v_pk_fma_f32 v[4:5], v[4:5], v[12:13], v[12:13] op_sel:[0,0,1] op_sel_hi:[1,0,1]
    v_cvt_pk_bf16_f32 v76, v4, v5
    v_lshlrev_b32 v6, 16, v77
    v_and_b32 v7, s25, v77
    v_pk_fma_f32 v[6:7], v[6:7], v[12:13], v[12:13] op_sel:[0,0,1] op_sel_hi:[1,0,1]
    v_cvt_pk_bf16_f32 v77, v6, v7
    v_lshlrev_b32 v4, 16, v78
    v_and_b32 v5, s25, v78
    v_pk_fma_f32 v[4:5], v[4:5], v[12:13], v[12:13] op_sel:[0,0,1] op_sel_hi:[1,0,1]
    v_cvt_pk_bf16_f32 v78, v4, v5
    v_lshlrev_b32 v6, 16, v79
    v_and_b32 v7, s25, v79
    v_pk_fma_f32 v[6:7], v[6:7], v[12:13], v[12:13] op_sel:[0,0,1] op_sel_hi:[1,0,1]
    v_cvt_pk_bf16_f32 v79, v6, v7
    buffer_store_dwordx4 v[64:67], v1, s[16:19], s73 offen offset:0 sc1
    buffer_store_dwordx4 v[68:71], v1, s[16:19], s73 offen offset:1024 sc1
    buffer_store_dwordx4 v[72:75], v1, s[16:19], s73 offen offset:2048 sc1
    buffer_store_dwordx4 v[76:79], v1, s[16:19], s73 offen offset:3072 sc1
    buffer_store_dwordx4 v[48:51], v1, s[16:19], s72 offen offset:0 sc1
    buffer_store_dwordx4 v[52:55], v1, s[16:19], s72 offen offset:1024 sc1
    buffer_store_dwordx4 v[56:59], v1, s[16:19], s72 offen offset:2048 sc1
    buffer_store_dwordx4 v[60:63], v1, s[16:19], s72 offen offset:3072 sc1
    v_mov_b32 v12, 0
    v_mov_b32 v13, 0
    s_waitcnt vmcnt(27)
    v_dot2c_f32_bf16 v12, s32, v80
    v_dot2c_f32_bf16 v13, v80, v80
    v_dot2c_f32_bf16 v12, s32, v81
    v_dot2c_f32_bf16 v13, v81, v81
    v_dot2c_f32_bf16 v12, s32, v82
    v_dot2c_f32_bf16 v13, v82, v82
    v_dot2c_f32_bf16 v12, s32, v83
    v_dot2c_f32_bf16 v13, v83, v83
    s_waitcnt vmcnt(26)
    v_dot2c_f32_bf16 v12, s32, v84
    v_dot2c_f32_bf16 v13, v84, v84
    v_dot2c_f32_bf16 v12, s32, v85
    v_dot2c_f32_bf16 v13, v85, v85
    v_dot2c_f32_bf16 v12, s32, v86
    v_dot2c_f32_bf16 v13, v86, v86
    v_dot2c_f32_bf16 v12, s32, v87
    v_dot2c_f32_bf16 v13, v87, v87
    s_waitcnt vmcnt(25)
    v_dot2c_f32_bf16 v12, s32, v88
    v_dot2c_f32_bf16 v13, v88, v88
    v_dot2c_f32_bf16 v12, s32, v89
    v_dot2c_f32_bf16 v13, v89, v89
    v_dot2c_f32_bf16 v12, s32, v90
    v_dot2c_f32_bf16 v13, v90, v90
    v_dot2c_f32_bf16 v12, s32, v91
    v_dot2c_f32_bf16 v13, v91, v91
    s_waitcnt vmcnt(24)
    v_dot2c_f32_bf16 v12, s32, v92
    v_dot2c_f32_bf16 v13, v92, v92
    v_dot2c_f32_bf16 v12, s32, v93
    v_dot2c_f32_bf16 v13, v93, v93
    v_dot2c_f32_bf16 v12, s32, v94
    v_dot2c_f32_bf16 v13, v94, v94
    v_dot2c_f32_bf16 v12, s32, v95
    v_dot2c_f32_bf16 v13, v95, v95
    v_readfirstlane_b32 s34, v80
    s_lshl_b32 s35, s34, 16
    v_mov_b32 v10, s35
    v_fmamk_f32 v8, v10, 0xc2000000, v12
    v_add_f32 v9, v12, v8
    v_fma_f32 v9, -v10, v9, v13
    s_nop 1
    v_add_f32_dpp v8, v8, v8 row_ror:8 row_mask:0xf bank_mask:0xf
    v_add_f32_dpp v9, v9, v9 row_ror:8 row_mask:0xf bank_mask:0xf
    s_nop 1
    v_add_f32_dpp v8, v8, v8 row_ror:4 row_mask:0xf bank_mask:0xf
    v_add_f32_dpp v9, v9, v9 row_ror:4 row_mask:0xf bank_mask:0xf
    s_nop 1
    v_add_f32_dpp v8, v8, v8 row_ror:2 row_mask:0xf bank_mask:0xf
    v_add_f32_dpp v9, v9, v9 row_ror:2 row_mask:0xf bank_mask:0xf
    s_nop 1
    v_add_f32_dpp v8, v8, v8 row_ror:1 row_mask:0xf bank_mask:0xf
    v_add_f32_dpp v9, v9, v9 row_ror:1 row_mask:0xf bank_mask:0xf
    s_nop 1
    v_add_f32_dpp v8, v8, v8 row_bcast:15 row_mask:0xa bank_mask:0xf
    v_add_f32_dpp v9, v9, v9 row_bcast:15 row_mask:0xa bank_mask:0xf
    s_mov_b32 exec_lo, s25
    s_mov_b32 exec_hi, s25
    ds_write_b96 v2, v[8:10] offset:1024
    s_mov_b64 exec, 1
    ds_add_u32 v14, v15 offset:2192
    s_mov_b64 exec, -1
    v_mov_b32 v12, 0
    v_mov_b32 v13, 0
    s_waitcnt vmcnt(11)
    v_dot2c_f32_bf16 v12, s32, v112
    v_dot2c_f32_bf16 v13, v112, v112
    v_dot2c_f32_bf16 v12, s32, v113
    v_dot2c_f32_bf16 v13, v113, v113
    v_dot2c_f32_bf16 v12, s32, v114
    v_dot2c_f32_bf16 v13, v114, v114
    v_dot2c_f32_bf16 v12, s32, v115
    v_dot2c_f32_bf16 v13, v115, v115
    s_waitcnt vmcnt(10)
    v_dot2c_f32_bf16 v12, s32, v116
    v_dot2c_f32_bf16 v13, v116, v116
    v_dot2c_f32_bf16 v12, s32, v117
    v_dot2c_f32_bf16 v13, v117, v117
    v_dot2c_f32_bf16 v12, s32, v118
    v_dot2c_f32_bf16 v13, v118, v118
    v_dot2c_f32_bf16 v12, s32, v119
    v_dot2c_f32_bf16 v13, v119, v119
    s_waitcnt vmcnt(9)
    v_dot2c_f32_bf16 v12, s32, v120
    v_dot2c_f32_bf16 v13, v120, v120
    v_dot2c_f32_bf16 v12, s32, v121
    v_dot2c_f32_bf16 v13, v121, v121
    v_dot2c_f32_bf16 v12, s32, v122
    v_dot2c_f32_bf16 v13, v122, v122
    v_dot2c_f32_bf16 v12, s32, v123
    v_dot2c_f32_bf16 v13, v123, v123
    s_waitcnt vmcnt(8)
    v_dot2c_f32_bf16 v12, s32, v124
    v_dot2c_f32_bf16 v13, v124, v124
    v_dot2c_f32_bf16 v12, s32, v125
    v_dot2c_f32_bf16 v13, v125, v125
    v_dot2c_f32_bf16 v12, s32, v126
    v_dot2c_f32_bf16 v13, v126, v126
    v_dot2c_f32_bf16 v12, s32, v127
    v_dot2c_f32_bf16 v13, v127, v127
    v_readfirstlane_b32 s34, v112
    s_lshl_b32 s35, s34, 16
    v_mov_b32 v10, s35
    v_fmamk_f32 v8, v10, 0xc2000000, v12
    v_add_f32 v9, v12, v8
    v_fma_f32 v9, -v10, v9, v13
    s_nop 1
    v_add_f32_dpp v8, v8, v8 row_ror:8 row_mask:0xf bank_mask:0xf
    v_add_f32_dpp v9, v9, v9 row_ror:8 row_mask:0xf bank_mask:0xf
    s_nop 1
    v_add_f32_dpp v8, v8, v8 row_ror:4 row_mask:0xf bank_mask:0xf
    v_add_f32_dpp v9, v9, v9 row_ror:4 row_mask:0xf bank_mask:0xf
    s_nop 1
    v_add_f32_dpp v8, v8, v8 row_ror:2 row_mask:0xf bank_mask:0xf
    v_add_f32_dpp v9, v9, v9 row_ror:2 row_mask:0xf bank_mask:0xf
    s_nop 1
    v_add_f32_dpp v8, v8, v8 row_ror:1 row_mask:0xf bank_mask:0xf
    v_add_f32_dpp v9, v9, v9 row_ror:1 row_mask:0xf bank_mask:0xf
    s_nop 1
    v_add_f32_dpp v8, v8, v8 row_bcast:15 row_mask:0xa bank_mask:0xf
    v_add_f32_dpp v9, v9, v9 row_bcast:15 row_mask:0xa bank_mask:0xf
    s_mov_b32 exec_lo, s25
    s_mov_b32 exec_hi, s25
    ds_write_b96 v2, v[8:10] offset:1536
    s_mov_b64 exec, 1
    ds_add_u32 v14, v15 offset:2200
    s_mov_b64 exec, -1
    s_setprio 0
    buffer_load_dwordx4 v[128:131], v1, s[12:15], s77 offen offset:0 nt
    buffer_load_dwordx4 v[132:135], v1, s[12:15], s77 offen offset:1024 nt
    buffer_load_dwordx4 v[136:139], v1, s[12:15], s77 offen offset:2048 nt
    buffer_load_dwordx4 v[140:143], v1, s[12:15], s77 offen offset:3072 nt
L_fin5:
    ds_read_b96 v[8:10], v14 offset:2128
    s_waitcnt lgkmcnt(0)
    v_cmp_ne_u32 vcc, 1, v10
    s_cbranch_vccz L_go5
    v_cmp_eq_u32 vcc, 0, v10
    s_cbranch_vccz L_pre5
    s_sleep 1
    s_branch L_fin5
L_go5:
    s_bfe_u32 m0, s75, 0x2000c
    s_nop 0
    s_movrels_b32 s84, s52
    s_movrels_b32 s86, s56
    s_lshl_b32 s34, s84, 16
    s_lshl_b32 s35, s86, 16
    v_mul_f32 v12, s34, v9
    v_fma_f32 v13, -v8, v12, s35
    v_lshlrev_b32 v4, 16, v96
    v_and_b32 v5, s25, v96
    v_pk_fma_f32 v[4:5], v[4:5], v[12:13], v[12:13] op_sel:[0,0,1] op_sel_hi:[1,0,1]
    v_cvt_pk_bf16_f32 v96, v4, v5
    v_lshlrev_b32 v6, 16, v97
    v_and_b32 v7, s25, v97
    v_pk_fma_f32 v[6:7], v[6:7], v[12:13], v[12:13] op_sel:[0,0,1] op_sel_hi:[1,0,1]
    v_cvt_pk_bf16_f32 v97, v6, v7
    v_lshlrev_b32 v4, 16, v98
    v_and_b32 v5, s25, v98
    v_pk_fma_f32 v[4:5], v[4:5], v[12:13], v[12:13] op_sel:[0,0,1] op_sel_hi:[1,0,1]
    v_cvt_pk_bf16_f32 v98, v4, v5
    v_lshlrev_b32 v6, 16, v99
    v_and_b32 v7, s25, v99
    v_pk_fma_f32 v[6:7], v[6:7], v[12:13], v[12:13] op_sel:[0,0,1] op_sel_hi:[1,0,1]
    v_cvt_pk_bf16_f32 v99, v6, v7
    v_lshlrev_b32 v4, 16, v100
    v_and_b32 v5, s25, v100
    v_pk_fma_f32 v[4:5], v[4:5], v[12:13], v[12:13] op_sel:[0,0,1] op_sel_hi:[1,0,1]
    v_cvt_pk_bf16_f32 v100, v4, v5
    v_lshlrev_b32 v6, 16, v101
    v_and_b32 v7, s25, v101
    v_pk_fma_f32 v[6:7], v[6:7], v[12:13], v[12:13] op_sel:[0,0,1] op_sel_hi:[1,0,1]
    v_cvt_pk_bf16_f32 v101, v6, v7
    v_lshlrev_b32 v4, 16, v102
    v_and_b32 v5, s25, v102
    v_pk_fma_f32 v[4:5], v[4:5], v[12:13], v[12:13] op_sel:[0,0,1] op_sel_hi:[1,0,1]
    v_cvt_pk_bf16_f32 v102, v4, v5
    v_lshlrev_b32 v6, 16, v103
    v_and_b32 v7, s25, v103
    v_pk_fma_f32 v[6:7], v[6:7], v[12:13], v[12:13] op_sel:[0,0,1] op_sel_hi:[1,0,1]
    v_cvt_pk_bf16_f32 v103, v6, v7
    s_and_b32 s34, s84, s25
    s_and_b32 s35, s86, s25
    v_mul_f32 v12, s34, v9
    v_fma_f32 v13, -v8, v12, s35
    v_lshlrev_b32 v4, 16, v104
    v_and_b32 v5, s25, v104
    v_pk_fma_f32 v[4:5], v[4:5], v[12:13], v[12:13] op_sel:[0,0,1] op_sel_hi:[1,0,1]
    v_cvt_pk_bf16_f32 v104, v4, v5
    v_lshlrev_b32 v6, 16, v105
    v_and_b32 v7, s25, v105
    v_pk_fma_f32 v[6:7], v[6:7], v[12:13], v[12:13] op_sel:[0,0,1] op_sel_hi:[1,0,1]
    v_cvt_pk_bf16_f32 v105, v6, v7
    v_lshlrev_b32 v4, 16, v106
    v_and_b32 v5, s25, v106
    v_pk_fma_f32 v[4:5], v[4:5], v[12:13], v[12:13] op_sel:[0,0,1] op_sel_hi:[1,0,1]
    v_cvt_pk_bf16_f32 v106, v4, v5
    v_lshlrev_b32 v6, 16, v107
    v_and_b32 v7, s25, v107
    v_pk_fma_f32 v[6:7], v[6:7], v[12:13], v[12:13] op_sel:[0,0,1] op_sel_hi:[1,0,1]
    v_cvt_pk_bf16_f32 v107, v6, v7
    v_lshlrev_b32 v4, 16, v108
    v_and_b32 v5, s25, v108
    v_pk_fma_f32 v[4:5], v[4:5], v[12:13], v[12:13] op_sel:[0,0,1] op_sel_hi:[1,0,1]
    v_cvt_pk_bf16_f32 v108, v4, v5
    v_lshlrev_b32 v6, 16, v109
    v_and_b32 v7, s25, v109
    v_pk_fma_f32 v[6:7], v[6:7], v[12:13], v[12:13] op_sel:[0,0,1] op_sel_hi:[1,0,1]
    v_cvt_pk_bf16_f32 v109, v6, v7
    v_lshlrev_b32 v4, 16, v110
    v_and_b32 v5, s25, v110
    v_pk_fma_f32 v[4:5], v[4:5], v[12:13], v[12:13] op_sel:[0,0,1] op_sel_hi:[1,0,1]
    v_cvt_pk_bf16_f32 v110, v4, v5
    v_lshlrev_b32 v6, 16, v111
    v_and_b32 v7, s25, v111
    v_pk_fma_f32 v[6:7], v[6:7], v[12:13], v[12:13] op_sel:[0,0,1] op_sel_hi:[1,0,1]
    v_cvt_pk_bf16_f32 v111, v6, v7
    v_mov_b32 v12, 0
    v_mov_b32 v13, 0
    s_waitcnt vmcnt(3)
    v_dot2c_f32_bf16 v12, s32, v128
    v_dot2c_f32_bf16 v13, v128, v128
    v_dot2c_f32_bf16 v12, s32, v129
    v_dot2c_f32_bf16 v13, v129, v129
    v_dot2c_f32_bf16 v12, s32, v130
    v_dot2c_f32_bf16 v13, v130, v130
    v_dot2c_f32_bf16 v12, s32, v131
    v_dot2c_f32_bf16 v13, v131, v131
    s_waitcnt vmcnt(2)
    v_dot2c_f32_bf16 v12, s32, v132
    v_dot2c_f32_bf16 v13, v132, v132
    v_dot2c_f32_bf16 v12, s32, v133
    v_dot2c_f32_bf16 v13, v133, v133
    v_dot2c_f32_bf16 v12, s32, v134
    v_dot2c_f32_bf16 v13, v134, v134
    v_dot2c_f32_bf16 v12, s32, v135
    v_dot2c_f32_bf16 v13, v135, v135
    s_waitcnt vmcnt(1)
    v_dot2c_f32_bf16 v12, s32, v136
    v_dot2c_f32_bf16 v13, v136, v136
    v_dot2c_f32_bf16 v12, s32, v137
    v_dot2c_f32_bf16 v13, v137, v137
    v_dot2c_f32_bf16 v12, s32, v138
    v_dot2c_f32_bf16 v13, v138, v138
    v_dot2c_f32_bf16 v12, s32, v139
    v_dot2c_f32_bf16 v13, v139, v139
    s_waitcnt vmcnt(0)
    v_dot2c_f32_bf16 v12, s32, v140
    v_dot2c_f32_bf16 v13, v140, v140
    v_dot2c_f32_bf16 v12, s32, v141
    v_dot2c_f32_bf16 v13, v141, v141
    v_dot2c_f32_bf16 v12, s32, v142
    v_dot2c_f32_bf16 v13, v142, v142
    v_dot2c_f32_bf16 v12, s32, v143
    v_dot2c_f32_bf16 v13, v143, v143
    v_readfirstlane_b32 s34, v128
    s_lshl_b32 s35, s34, 16
    v_mov_b32 v10, s35
    v_fmamk_f32 v8, v10, 0xc2000000, v12
    v_add_f32 v9, v12, v8
    v_fma_f32 v9, -v10, v9, v13
    s_nop 1
    v_add_f32_dpp v8, v8, v8 row_ror:8 row_mask:0xf bank_mask:0xf
    v_add_f32_dpp v9, v9, v9 row_ror:8 row_mask:0xf bank_mask:0xf
    s_nop 1
    v_add_f32_dpp v8, v8, v8 row_ror:4 row_mask:0xf bank_mask:0xf
    v_add_f32_dpp v9, v9, v9 row_ror:4 row_mask:0xf bank_mask:0xf
    s_nop 1
    v_add_f32_dpp v8, v8, v8 row_ror:2 row_mask:0xf bank_mask:0xf
    v_add_f32_dpp v9, v9, v9 row_ror:2 row_mask:0xf bank_mask:0xf
    s_nop 1
    v_add_f32_dpp v8, v8, v8 row_ror:1 row_mask:0xf bank_mask:0xf
    v_add_f32_dpp v9, v9, v9 row_ror:1 row_mask:0xf bank_mask:0xf
    s_nop 1
    v_add_f32_dpp v8, v8, v8 row_bcast:15 row_mask:0xa bank_mask:0xf
    v_add_f32_dpp v9, v9, v9 row_bcast:15 row_mask:0xa bank_mask:0xf
    s_mov_b32 exec_lo, s25
    s_mov_b32 exec_hi, s25
    ds_write_b96 v2, v[8:10] offset:1792
    s_mov_b64 exec, 1
    ds_add_u32 v14, v15 offset:2204
    s_mov_b64 exec, -1
L_fin4:
    ds_read_b96 v[8:10], v14 offset:2112
    s_waitcnt lgkmcnt(0)
    v_cmp_ne_u32 vcc, 1, v10
    s_cbranch_vccz L_go4
    v_cmp_eq_u32 vcc, 0, v10
    s_cbranch_vccz L_pre4
    s_sleep 1
    s_branch L_fin4
L_go4:
    s_bfe_u32 m0, s74, 0x2000c
    s_nop 0
    s_movrels_b32 s84, s52
    s_movrels_b32 s86, s56
    s_lshl_b32 s34, s84, 16
    s_lshl_b32 s35, s86, 16
    v_mul_f32 v12, s34, v9
    v_fma_f32 v13, -v8, v12, s35
    v_lshlrev_b32 v4, 16, v80
    v_and_b32 v5, s25, v80
    v_pk_fma_f32 v[4:5], v[4:5], v[12:13], v[12:13] op_sel:[0,0,1] op_sel_hi:[1,0,1]
    v_cvt_pk_bf16_f32 v80, v4, v5
    v_lshlrev_b32 v6, 16, v81
    v_and_b32 v7, s25, v81
    v_pk_fma_f32 v[6:7], v[6:7], v[12:13], v[12:13] op_sel:[0,0,1] op_sel_hi:[1,0,1]
    v_cvt_pk_bf16_f32 v81, v6, v7
    v_lshlrev_b32 v4, 16, v82
    v_and_b32 v5, s25, v82
    v_pk_fma_f32 v[4:5], v[4:5], v[12:13], v[12:13] op_sel:[0,0,1] op_sel_hi:[1,0,1]
    v_cvt_pk_bf16_f32 v82, v4, v5
    v_lshlrev_b32 v6, 16, v83
    v_and_b32 v7, s25, v83
    v_pk_fma_f32 v[6:7], v[6:7], v[12:13], v[12:13] op_sel:[0,0,1] op_sel_hi:[1,0,1]
    v_cvt_pk_bf16_f32 v83, v6, v7
    v_lshlrev_b32 v4, 16, v84
    v_and_b32 v5, s25, v84
    v_pk_fma_f32 v[4:5], v[4:5], v[12:13], v[12:13] op_sel:[0,0,1] op_sel_hi:[1,0,1]
    v_cvt_pk_bf16_f32 v84, v4, v5
    v_lshlrev_b32 v6, 16, v85
    v_and_b32 v7, s25, v85
    v_pk_fma_f32 v[6:7], v[6:7], v[12:13], v[12:13] op_sel:[0,0,1] op_sel_hi:[1,0,1]
    v_cvt_pk_bf16_f32 v85, v6, v7
    v_lshlrev_b32 v4, 16, v86
    v_and_b32 v5, s25, v86
    v_pk_fma_f32 v[4:5], v[4:5], v[12:13], v[12:13] op_sel:[0,0,1] op_sel_hi:[1,0,1]
    v_cvt_pk_bf16_f32 v86, v4, v5
    v_lshlrev_b32 v6, 16, v87
    v_and_b32 v7, s25, v87
    v_pk_fma_f32 v[6:7], v[6:7], v[12:13], v[12:13] op_sel:[0,0,1] op_sel_hi:[1,0,1]
    v_cvt_pk_bf16_f32 v87, v6, v7
    s_and_b32 s34, s84, s25
    s_and_b32 s35, s86, s25
    v_mul_f32 v12, s34, v9
    v_fma_f32 v13, -v8, v12, s35
    v_lshlrev_b32 v4, 16, v88
    v_and_b32 v5, s25, v88
    v_pk_fma_f32 v[4:5], v[4:5], v[12:13], v[12:13] op_sel:[0,0,1] op_sel_hi:[1,0,1]
    v_cvt_pk_bf16_f32 v88, v4, v5
    v_lshlrev_b32 v6, 16, v89
    v_and_b32 v7, s25, v89
    v_pk_fma_f32 v[6:7], v[6:7], v[12:13], v[12:13] op_sel:[0,0,1] op_sel_hi:[1,0,1]
    v_cvt_pk_bf16_f32 v89, v6, v7
    v_lshlrev_b32 v4, 16, v90
    v_and_b32 v5, s25, v90
    v_pk_fma_f32 v[4:5], v[4:5], v[12:13], v[12:13] op_sel:[0,0,1] op_sel_hi:[1,0,1]
    v_cvt_pk_bf16_f32 v90, v4, v5
    v_lshlrev_b32 v6, 16, v91
    v_and_b32 v7, s25, v91
    v_pk_fma_f32 v[6:7], v[6:7], v[12:13], v[12:13] op_sel:[0,0,1] op_sel_hi:[1,0,1]
    v_cvt_pk_bf16_f32 v91, v6, v7
    v_lshlrev_b32 v4, 16, v92
    v_and_b32 v5, s25, v92
    v_pk_fma_f32 v[4:5], v[4:5], v[12:13], v[12:13] op_sel:[0,0,1] op_sel_hi:[1,0,1]
    v_cvt_pk_bf16_f32 v92, v4, v5
    v_lshlrev_b32 v6, 16, v93
    v_and_b32 v7, s25, v93
    v_pk_fma_f32 v[6:7], v[6:7], v[12:13], v[12:13] op_sel:[0,0,1] op_sel_hi:[1,0,1]
    v_cvt_pk_bf16_f32 v93, v6, v7
    v_lshlrev_b32 v4, 16, v94
    v_and_b32 v5, s25, v94
    v_pk_fma_f32 v[4:5], v[4:5], v[12:13], v[12:13] op_sel:[0,0,1] op_sel_hi:[1,0,1]
    v_cvt_pk_bf16_f32 v94, v4, v5
    v_lshlrev_b32 v6, 16, v95
    v_and_b32 v7, s25, v95
    v_pk_fma_f32 v[6:7], v[6:7], v[12:13], v[12:13] op_sel:[0,0,1] op_sel_hi:[1,0,1]
    v_cvt_pk_bf16_f32 v95, v6, v7
    buffer_store_dwordx4 v[80:83], v1, s[16:19], s74 offen offset:0 sc1
    buffer_store_dwordx4 v[84:87], v1, s[16:19], s74 offen offset:1024 sc1
    buffer_store_dwordx4 v[88:91], v1, s[16:19], s74 offen offset:2048 sc1
    buffer_store_dwordx4 v[92:95], v1, s[16:19], s74 offen offset:3072 sc1
    buffer_store_dwordx4 v[96:99], v1, s[16:19], s75 offen offset:0 sc1
    buffer_store_dwordx4 v[100:103], v1, s[16:19], s75 offen offset:1024 sc1
    buffer_store_dwordx4 v[104:107], v1, s[16:19], s75 offen offset:2048 sc1
    buffer_store_dwordx4 v[108:111], v1, s[16:19], s75 offen offset:3072 sc1
L_fin6:
    ds_read_b96 v[8:10], v14 offset:2144
    s_waitcnt lgkmcnt(0)
    v_cmp_ne_u32 vcc, 1, v10
    s_cbranch_vccz L_go6
    v_cmp_eq_u32 vcc, 0, v10
    s_cbranch_vccz L_pre6
    s_sleep 1
    s_branch L_fin6
L_go6:
    s_bfe_u32 m0, s76, 0x2000c
    s_nop 0
    s_movrels_b32 s84, s52
    s_movrels_b32 s86, s56
    s_lshl_b32 s34, s84, 16
    s_lshl_b32 s35, s86, 16
    v_mul_f32 v12, s34, v9
    v_fma_f32 v13, -v8, v12, s35
    v_lshlrev_b32 v4, 16, v112
    v_and_b32 v5, s25, v112
    v_pk_fma_f32 v[4:5], v[4:5], v[12:13], v[12:13] op_sel:[0,0,1] op_sel_hi:[1,0,1]
    v_cvt_pk_bf16_f32 v112, v4, v5
    v_lshlrev_b32 v6, 16, v113
    v_and_b32 v7, s25, v113
    v_pk_fma_f32 v[6:7], v[6:7], v[12:13], v[12:13] op_sel:[0,0,1] op_sel_hi:[1,0,1]
    v_cvt_pk_bf16_f32 v113, v6, v7
    v_lshlrev_b32 v4, 16, v114
    v_and_b32 v5, s25, v114
    v_pk_fma_f32 v[4:5], v[4:5], v[12:13], v[12:13] op_sel:[0,0,1] op_sel_hi:[1,0,1]
    v_cvt_pk_bf16_f32 v114, v4, v5
    v_lshlrev_b32 v6, 16, v115
    v_and_b32 v7, s25, v115
    v_pk_fma_f32 v[6:7], v[6:7], v[12:13], v[12:13] op_sel:[0,0,1] op_sel_hi:[1,0,1]
    v_cvt_pk_bf16_f32 v115, v6, v7
    v_lshlrev_b32 v4, 16, v116
    v_and_b32 v5, s25, v116
    v_pk_fma_f32 v[4:5], v[4:5], v[12:13], v[12:13] op_sel:[0,0,1] op_sel_hi:[1,0,1]
    v_cvt_pk_bf16_f32 v116, v4, v5
    v_lshlrev_b32 v6, 16, v117
    v_and_b32 v7, s25, v117
    v_pk_fma_f32 v[6:7], v[6:7], v[12:13], v[12:13] op_sel:[0,0,1] op_sel_hi:[1,0,1]
    v_cvt_pk_bf16_f32 v117, v6, v7
    v_lshlrev_b32 v4, 16, v118
    v_and_b32 v5, s25, v118
    v_pk_fma_f32 v[4:5], v[4:5], v[12:13], v[12:13] op_sel:[0,0,1] op_sel_hi:[1,0,1]
    v_cvt_pk_bf16_f32 v118, v4, v5
    v_lshlrev_b32 v6, 16, v119
    v_and_b32 v7, s25, v119
    v_pk_fma_f32 v[6:7], v[6:7], v[12:13], v[12:13] op_sel:[0,0,1] op_sel_hi:[1,0,1]
    v_cvt_pk_bf16_f32 v119, v6, v7
    s_and_b32 s34, s84, s25
    s_and_b32 s35, s86, s25
    v_mul_f32 v12, s34, v9
    v_fma_f32 v13, -v8, v12, s35
    v_lshlrev_b32 v4, 16, v120
    v_and_b32 v5, s25, v120
    v_pk_fma_f32 v[4:5], v[4:5], v[12:13], v[12:13] op_sel:[0,0,1] op_sel_hi:[1,0,1]
    v_cvt_pk_bf16_f32 v120, v4, v5
    v_lshlrev_b32 v6, 16, v121
    v_and_b32 v7, s25, v121
    v_pk_fma_f32 v[6:7], v[6:7], v[12:13], v[12:13] op_sel:[0,0,1] op_sel_hi:[1,0,1]
    v_cvt_pk_bf16_f32 v121, v6, v7
    v_lshlrev_b32 v4, 16, v122
    v_and_b32 v5, s25, v122
    v_pk_fma_f32 v[4:5], v[4:5], v[12:13], v[12:13] op_sel:[0,0,1] op_sel_hi:[1,0,1]
    v_cvt_pk_bf16_f32 v122, v4, v5
    v_lshlrev_b32 v6, 16, v123
    v_and_b32 v7, s25, v123
    v_pk_fma_f32 v[6:7], v[6:7], v[12:13], v[12:13] op_sel:[0,0,1] op_sel_hi:[1,0,1]
    v_cvt_pk_bf16_f32 v123, v6, v7
    v_lshlrev_b32 v4, 16, v124
    v_and_b32 v5, s25, v124
    v_pk_fma_f32 v[4:5], v[4:5], v[12:13], v[12:13] op_sel:[0,0,1] op_sel_hi:[1,0,1]
    v_cvt_pk_bf16_f32 v124, v4, v5
    v_lshlrev_b32 v6, 16, v125
    v_and_b32 v7, s25, v125
    v_pk_fma_f32 v[6:7], v[6:7], v[12:13], v[12:13] op_sel:[0,0,1] op_sel_hi:[1,0,1]
    v_cvt_pk_bf16_f32 v125, v6, v7
    v_lshlrev_b32 v4, 16, v126
    v_and_b32 v5, s25, v126
    v_pk_fma_f32 v[4:5], v[4:5], v[12:13], v[12:13] op_sel:[0,0,1] op_sel_hi:[1,0,1]
    v_cvt_pk_bf16_f32 v126, v4, v5
    v_lshlrev_b32 v6, 16, v127
    v_and_b32 v7, s25, v127
    v_pk_fma_f32 v[6:7], v[6:7], v[12:13], v[12:13] op_sel:[0,0,1] op_sel_hi:[1,0,1]
    v_cvt_pk_bf16_f32 v127, v6, v7
    buffer_store_dwordx4 v[112:115], v1, s[16:19], s76 offen offset:0 sc1
    buffer_store_dwordx4 v[116:119], v1, s[16:19], s76 offen offset:1024 sc1
    buffer_store_dwordx4 v[120:123], v1, s[16:19], s76 offen offset:2048 sc1
    buffer_store_dwordx4 v[124:127], v1, s[16:19], s76 offen offset:3072 sc1
L_fin7:
    ds_read_b96 v[8:10], v14 offset:2160
    s_waitcnt lgkmcnt(0)
    v_cmp_ne_u32 vcc, 1, v10
    s_cbranch_vccz L_go7
    v_cmp_eq_u32 vcc, 0, v10
    s_cbranch_vccz L_pre7
    s_sleep 1
    s_branch L_fin7
L_go7:
    s_bfe_u32 m0, s77, 0x2000c
    s_nop 0
    s_movrels_b32 s84, s52
    s_movrels_b32 s86, s56
    s_lshl_b32 s34, s84, 16
    s_lshl_b32 s35, s86, 16
    v_mul_f32 v12, s34, v9
    v_fma_f32 v13, -v8, v12, s35
    v_lshlrev_b32 v4, 16, v128
    v_and_b32 v5, s25, v128
    v_pk_fma_f32 v[4:5], v[4:5], v[12:13], v[12:13] op_sel:[0,0,1] op_sel_hi:[1,0,1]
    v_cvt_pk_bf16_f32 v128, v4, v5
    v_lshlrev_b32 v6, 16, v129
    v_and_b32 v7, s25, v129
    v_pk_fma_f32 v[6:7], v[6:7], v[12:13], v[12:13] op_sel:[0,0,1] op_sel_hi:[1,0,1]
    v_cvt_pk_bf16_f32 v129, v6, v7
    v_lshlrev_b32 v4, 16, v130
    v_and_b32 v5, s25, v130
    v_pk_fma_f32 v[4:5], v[4:5], v[12:13], v[12:13] op_sel:[0,0,1] op_sel_hi:[1,0,1]
    v_cvt_pk_bf16_f32 v130, v4, v5
    v_lshlrev_b32 v6, 16, v131
    v_and_b32 v7, s25, v131
    v_pk_fma_f32 v[6:7], v[6:7], v[12:13], v[12:13] op_sel:[0,0,1] op_sel_hi:[1,0,1]
    v_cvt_pk_bf16_f32 v131, v6, v7
    v_lshlrev_b32 v4, 16, v132
    v_and_b32 v5, s25, v132
    v_pk_fma_f32 v[4:5], v[4:5], v[12:13], v[12:13] op_sel:[0,0,1] op_sel_hi:[1,0,1]
    v_cvt_pk_bf16_f32 v132, v4, v5
    v_lshlrev_b32 v6, 16, v133
    v_and_b32 v7, s25, v133
    v_pk_fma_f32 v[6:7], v[6:7], v[12:13], v[12:13] op_sel:[0,0,1] op_sel_hi:[1,0,1]
    v_cvt_pk_bf16_f32 v133, v6, v7
    v_lshlrev_b32 v4, 16, v134
    v_and_b32 v5, s25, v134
    v_pk_fma_f32 v[4:5], v[4:5], v[12:13], v[12:13] op_sel:[0,0,1] op_sel_hi:[1,0,1]
    v_cvt_pk_bf16_f32 v134, v4, v5
    v_lshlrev_b32 v6, 16, v135
    v_and_b32 v7, s25, v135
    v_pk_fma_f32 v[6:7], v[6:7], v[12:13], v[12:13] op_sel:[0,0,1] op_sel_hi:[1,0,1]
    v_cvt_pk_bf16_f32 v135, v6, v7
    s_and_b32 s34, s84, s25
    s_and_b32 s35, s86, s25
    v_mul_f32 v12, s34, v9
    v_fma_f32 v13, -v8, v12, s35
    v_lshlrev_b32 v4, 16, v136
    v_and_b32 v5, s25, v136
    v_pk_fma_f32 v[4:5], v[4:5], v[12:13], v[12:13] op_sel:[0,0,1] op_sel_hi:[1,0,1]
    v_cvt_pk_bf16_f32 v136, v4, v5
    v_lshlrev_b32 v6, 16, v137
    v_and_b32 v7, s25, v137
    v_pk_fma_f32 v[6:7], v[6:7], v[12:13], v[12:13] op_sel:[0,0,1] op_sel_hi:[1,0,1]
    v_cvt_pk_bf16_f32 v137, v6, v7
    v_lshlrev_b32 v4, 16, v138
    v_and_b32 v5, s25, v138
    v_pk_fma_f32 v[4:5], v[4:5], v[12:13], v[12:13] op_sel:[0,0,1] op_sel_hi:[1,0,1]
    v_cvt_pk_bf16_f32 v138, v4, v5
    v_lshlrev_b32 v6, 16, v139
    v_and_b32 v7, s25, v139
    v_pk_fma_f32 v[6:7], v[6:7], v[12:13], v[12:13] op_sel:[0,0,1] op_sel_hi:[1,0,1]
    v_cvt_pk_bf16_f32 v139, v6, v7
    v_lshlrev_b32 v4, 16, v140
    v_and_b32 v5, s25, v140
    v_pk_fma_f32 v[4:5], v[4:5], v[12:13], v[12:13] op_sel:[0,0,1] op_sel_hi:[1,0,1]
    v_cvt_pk_bf16_f32 v140, v4, v5
    v_lshlrev_b32 v6, 16, v141
    v_and_b32 v7, s25, v141
    v_pk_fma_f32 v[6:7], v[6:7], v[12:13], v[12:13] op_sel:[0,0,1] op_sel_hi:[1,0,1]
    v_cvt_pk_bf16_f32 v141, v6, v7
    v_lshlrev_b32 v4, 16, v142
    v_and_b32 v5, s25, v142
    v_pk_fma_f32 v[4:5], v[4:5], v[12:13], v[12:13] op_sel:[0,0,1] op_sel_hi:[1,0,1]
    v_cvt_pk_bf16_f32 v142, v4, v5
    v_lshlrev_b32 v6, 16, v143
    v_and_b32 v7, s25, v143
    v_pk_fma_f32 v[6:7], v[6:7], v[12:13], v[12:13] op_sel:[0,0,1] op_sel_hi:[1,0,1]
    v_cvt_pk_bf16_f32 v143, v6, v7
    buffer_store_dwordx4 v[128:131], v1, s[16:19], s77 offen offset:0 sc1
    buffer_store_dwordx4 v[132:135], v1, s[16:19], s77 offen offset:1024 sc1
    buffer_store_dwordx4 v[136:139], v1, s[16:19], s77 offen offset:2048 sc1
    buffer_store_dwordx4 v[140:143], v1, s[16:19], s77 offen offset:3072 sc1
L_end:
    s_endpgm
L_weak:
    s_mov_b32 s62, s60
    s_mov_b32 s54, s58
    s_barrier
    s_branch L_hvoter2
L_hvoter:
    s_mov_b32 s62, 0
L_hvoter2:
    v_and_b32 v1, 63, v0
    v_lshlrev_b32 v1, 4, v1
    v_mov_b32 v14, 0
    s_lshr_b32 s27, s2, 3
    s_add_u32 s26, s27, s2
    s_and_b32 s26, s26, 3
    s_lshl2_add_u32 s26, s27, s26
    s_branch L_hwait2
L_helper:
    s_mov_b32 s62, 0
    s_lshl_b32 s42, s3, 8
    s_add_u32 s42, s42, s2
L_hwait:
    s_sub_u32 s42, s42, 0x840
    s_cmp_ge_u32 s42, 64
    s_cbranch_scc1 L_nocpf
    s_getpc_b64 s[34:35]
L_pc:
    s_lshr_b32 s42, s42, 3
    s_lshl_b32 s42, s42, 7
    s_sub_u32 s34, s34, L_pc - standalone__groupnorm__sampling_kernel
    s_subb_u32 s35, s35, 0
    s_add_u32 s34, s34, s42
    s_addc_u32 s35, s35, 0
    s_load_dword s36, s[34:35], 0x0
    s_load_dword s36, s[34:35], 0x400
    s_load_dword s36, s[34:35], 0x800
    s_load_dword s36, s[34:35], 0xc00
    s_load_dword s36, s[34:35], 0x1000
    s_load_dword s36, s[34:35], 0x1400
    s_load_dword s36, s[34:35], 0x1800
    s_load_dword s36, s[34:35], 0x1c00
    s_load_dword s36, s[34:35], 0x2000
L_nocpf:
    v_lshrrev_b32 v2, 2, v1
    v_mov_b32 v14, 0
    ds_write_b32 v2, v14 offset:2048
    s_waitcnt lgkmcnt(0)
    s_barrier
L_hwait2:
    s_setprio 3
    s_and_b32 s24, s3, 1
    s_lshl_b32 s58, s2, 9
    s_add_u32 s58, s58, 0x400000
    s_add_u32 s66, s46, s58
    s_addc_u32 s67, s47, 0
    s_xor_b32 s58, s58, 0x800
    s_add_u32 s68, s46, s58
    s_addc_u32 s69, s47, 0
    s_cmp_eq_u32 s24, 0
    s_cbranch_scc1 L_hprep
    s_movk_i32 s58, 36
L_hw0:
    ds_read_b32 v4, v14 offset:2236
    s_waitcnt lgkmcnt(0)
    v_cmp_gt_u32 vcc, 3, v4
    s_cbranch_vccz L_hw1
    s_sleep 1
    s_sub_u32 s58, s58, 1
    s_cmp_lg_u32 s58, 0
    s_cbranch_scc1 L_hw0
L_hw1:
    s_load_dwordx8 s[72:79], s[44:45], 0x0
    s_movk_i32 s58, 3000
    s_waitcnt lgkmcnt(0)
L_hw2:
    s_and_b32 s59, s72, s76
    s_and_b32 s59, s59, s73
    s_and_b32 s59, s59, s74
    s_and_b32 s59, s59, s77
    s_and_b32 s59, s59, s78
    s_bitcmp1_b32 s59, 0
    s_cbranch_scc1 L_hgot
    s_sub_u32 s58, s58, 1
    s_cmp_lg_u32 s58, 0
    s_cbranch_scc1 L_hw3
    s_or_b32 s60, s56, 1
    s_mov_b32 s61, 0
    s_atomic_cmpswap s[60:61], s[44:45], 0x0
    s_atomic_cmpswap s[60:61], s[44:45], 0x4
    s_atomic_cmpswap s[60:61], s[44:45], 0x8
    s_atomic_cmpswap s[60:61], s[44:45], 0x10
    s_atomic_cmpswap s[60:61], s[44:45], 0x14
    s_atomic_cmpswap s[60:61], s[44:45], 0x18
    s_waitcnt lgkmcnt(0)
L_hw3:
    s_cmp_eq_u32 s62, 0
    s_cbranch_scc1 L_hw4
    s_mov_b32 s63, 0
    s_atomic_cmpswap s[62:63], s[44:45], s54
    s_waitcnt lgkmcnt(0)
    s_mov_b32 s62, 0
L_hw4:
    v_lshrrev_b32 v2, 2, v1
    global_load_dword v4, v2, s[44:45] sc1
    s_waitcnt vmcnt(0)
    v_readlane_b32 s72, v4, 0
    v_readlane_b32 s76, v4, 4
    v_readlane_b32 s73, v4, 1
    v_readlane_b32 s77, v4, 5
    v_readlane_b32 s74, v4, 2
    v_readlane_b32 s78, v4, 6
    s_branch L_hw2
L_hgot:
    s_and_b32 s58, s72, 2
    s_and_b32 s60, s73, 2
    s_add_u32 s58, s58, s60
    s_and_b32 s60, s74, 2
    s_add_u32 s58, s58, s60
    s_and_b32 s59, s76, 2
    s_and_b32 s60, s77, 2
    s_add_u32 s59, s59, s60
    s_and_b32 s60, s78, 2
    s_add_u32 s59, s59, s60
    s_cmp_gt_u32 s59, 3
    s_cselect_b32 s65, 2, 0
    s_cmp_gt_u32 s58, 3
    s_addc_u32 s65, s65, 0
    s_lshr_b32 s58, s72, 2
    s_add_u32 s58, s58, s2
    s_bitcmp1_b32 s58, 2
    s_cselect_b32 s59, 7, 4
    s_xor_b32 s65, s65, s59
    s_mul_i32 s64, s73, 0x9e3779b1
    s_lshr_b32 s58, s76, 5
    s_add_u32 s64, s64, s58
    s_xor_b32 s64, s64, s72
    v_mov_b32 v4, s65
    v_mov_b32 v5, s64
    ds_write_b64 v14, v[4:5] offset:2240
L_hprep:
    s_lshl_b32 s58, s24, 6
    s_load_dword s59, s[66:67], s58 glc
    v_and_b32 v2, 0xf0, v1
    v_mov_b32 v3, 0
    v_mov_b32 v15, 0
    s_mov_b32 s25, 0xffff0000
    s_cmp_eq_u32 s24, 0
    s_movk_i32 s23, 0x54
    s_cselect_b32 s23, 0xab, s23
    s_mov_b32 s21, 0x44800000
    s_mov_b32 s70, 0
L_hslot:
    s_bitcmp1_b32 s23, s70
    s_cbranch_scc0 L_hskip
L_hunit:
    ds_read_b32 v4, v15 offset:2176
    s_waitcnt lgkmcnt(0)
    v_cmp_gt_u32 vcc, 8, v4
    s_cbranch_vccz L_hred
    s_sleep 1
    s_branch L_hunit
L_hred:
    ds_read_b96 v[8:10], v2 offset:0
    ds_read_b64 v[6:7], v14 offset:2240
    s_waitcnt lgkmcnt(0)
    v_readfirstlane_b32 s65, v6
    v_readfirstlane_b32 s64, v7
    v_mov_b32_dpp v11, v10 row_newbcast:0 row_mask:0xf bank_mask:0xf
    v_sub_f32 v10, v10, v11
    v_fmamk_f32 v4, v10, 0x44800000, v8
    v_add_f32 v8, v8, v4
    v_fma_f32 v9, v10, v8, v9
    s_nop 1
    v_add_f32_dpp v4, v4, v4 row_ror:8 row_mask:0xf bank_mask:0xf
    v_add_f32_dpp v9, v9, v9 row_ror:8 row_mask:0xf bank_mask:0xf
    s_nop 1
    v_add_f32_dpp v4, v4, v4 row_ror:4 row_mask:0xf bank_mask:0xf
    v_add_f32_dpp v9, v9, v9 row_ror:4 row_mask:0xf bank_mask:0xf
    s_nop 1
    v_add_f32_dpp v4, v4, v4 row_ror:2 row_mask:0xf bank_mask:0xf
    v_add_f32_dpp v9, v9, v9 row_ror:2 row_mask:0xf bank_mask:0xf
    s_nop 1
    v_add_f32_dpp v4, v4, v4 row_ror:1 row_mask:0xf bank_mask:0xf
    v_add_f32_dpp v9, v9, v9 row_ror:1 row_mask:0xf bank_mask:0xf
    v_mul_f32 v5, 0x38800000, v4
    v_fma_f32 v9, -v4, v5, v9
    v_add_f32 v8, v11, v5
    v_max_f32 v9, 0, v9
    s_bitcmp1_b32 2, s70
    s_cbranch_scc1 L_hfin
    v_readfirstlane_b32 s80, v8
    v_readfirstlane_b32 s82, v9
    s_bitcmp1_b32 1, s70
    s_cbranch_scc1 L_hnext
    s_bitcmp1_b32 s65, 2
    s_cbranch_scc0 L_hred
    s_mov_b32 s72, s80
    s_mov_b32 s73, s64
    s_mov_b32 s74, s82
    s_mov_b32 s75, s64
    s_lshl_b32 s71, s70, 4
    s_add_u32 s58, s71, 8
    s_atomic_swap_x2 s[72:73], s[68:69], s71
    s_atomic_swap_x2 s[74:75], s[68:69], s58
    s_mov_b32 s59, 20000
L_hpoll:
    s_load_dwordx4 s[80:83], s[66:67], s71 glc
    s_waitcnt lgkmcnt(0)
    s_xor_b32 s81, s81, s64
    s_xor_b32 s83, s83, s64
    s_or_b32 s81, s81, s83
    s_cbranch_scc0 L_hfin
    s_sub_u32 s59, s59, 1
    s_cmp_lg_u32 s59, 0
    s_cbranch_scc1 L_hpoll
    s_branch L_hself
L_hfin:
    v_add_f32 v6, s80, v8
    v_add_f32 v9, s82, v9
    v_mul_f32 v6, 0.5, v6
    v_cvt_pk_bf16_f32 v6, v6, v6
    v_and_b32 v6, s25, v6
    v_sub_f32 v8, v8, v6
    v_sub_f32 v4, s80, v6
    v_mul_f32 v8, v8, v8
    v_mul_f32 v4, v4, v4
    v_mul_f32 v9, 0x38000000, v9
    v_add_f32 v4, v4, v8
    v_mov_b32 v8, v6
    v_fma_f32 v9, 0.5, v4, v9
    v_cvt_pk_bf16_f32 v9, v9, v9
    v_and_b32 v9, s25, v9
    v_add_f32 v9, 0x3727c5ac, v9
    v_cvt_pk_bf16_f32 v9, v9, v9
    v_and_b32 v9, s25, v9
    v_sqrt_f32 v9, v9
    v_mov_b32 v10, 1
    v_cvt_pk_bf16_f32 v9, v9, v9
    v_and_b32 v9, s25, v9
    v_rcp_f32 v9, v9
    s_mov_b64 exec, 1
    v_mul_f32 v4, v8, v9
    v_cmp_lt_f32 vcc, s21, abs(v4)
    s_nop 1
    v_addc_co_u32 v10, vcc, 0, v10, vcc
    ds_write_b96 v3, v[8:10] offset:2048
    s_bitcmp1_b32 2, s70
    s_cbranch_scc0 L_hone
    ds_write_b96 v3, v[8:10] offset:2032
L_hone:
    s_mov_b64 exec, -1
L_hnext:
L_hskip:
    v_add_u32 v2, 0x100, v2
    v_add_u32 v3, 16, v3
    v_add_u32 v15, 4, v15
    s_add_u32 s70, s70, 1
    s_cmp_lt_u32 s70, 8
    s_cbranch_scc1 L_hslot
    s_waitcnt lgkmcnt(0)
    s_endpgm
L_hself:
    s_mov_b32 s12, s4
    s_mov_b32 s13, s5
    s_mov_b32 s14, 0x4000000
    s_mov_b32 s15, 0x20000
    s_mov_b32 s32, 0x3f803f80
    s_xor_b32 s33, s65, 3
    s_lshl_b32 s35, s70, 7
    s_add_u32 s35, s35, s26
    s_lshl_b32 s35, s35, 16
    s_and_b32 s41, s72, s25
    v_mov_b32 v20, s41
    v_mov_b32 v22, 0
    v_mov_b32 v23, 0
L_hs_blk:
    s_bitcmp1_b32 4, s70
    s_cbranch_scc0 L_hs_nc
    s_lshl_b32 s36, s2, 12
    s_xor_b32 s36, s36, s35
    s_andn2_b32 s36, 0x4000, s36
    s_lshr_b32 s36, s36, 1
    s_add_u32 s52, s35, s36
    s_add_u32 s53, s52, 0x1000
    s_branch L_hs_ld
L_hs_nc:
    s_bitcmp1_b32 72, s70
    s_cbranch_scc1 L_hs_o
    s_add_u32 s36, s35, s4
    s_lshr_b32 s36, s36, 20
    s_xor_b32 s36, s36, s33
    s_bfe_u32 s36, s36, 0x10001
    s_lshl_b32 s36, s36, 13
    s_sub_u32 s36, s36, s4
    s_add_u32 s37, s36, 0x1000
    s_and_b32 s36, s36, 0x3000
    s_and_b32 s37, s37, 0x3000
    s_add_u32 s52, s35, s36
    s_add_u32 s53, s35, s37
    s_branch L_hs_ld
L_hs_o:
    s_add_u32 s36, s35, s10
    s_lshr_b32 s36, s36, 21
    s_xor_b32 s36, s36, s33
    s_bfe_u32 s36, s36, 0x10000
    s_lshl_b32 s36, s36, 13
    s_sub_u32 s36, s36, s10
    s_add_u32 s37, s36, 0x1000
    s_and_b32 s36, s36, 0x3000
    s_and_b32 s37, s37, 0x3000
    s_add_u32 s52, s35, s36
    s_add_u32 s53, s35, s37
L_hs_ld:
    buffer_load_dwordx4 v[32:35], v1, s[12:15], s52 offen offset:0
    buffer_load_dwordx4 v[36:39], v1, s[12:15], s52 offen offset:1024
    buffer_load_dwordx4 v[40:43], v1, s[12:15], s52 offen offset:2048
    buffer_load_dwordx4 v[44:47], v1, s[12:15], s52 offen offset:3072
    buffer_load_dwordx4 v[48:51], v1, s[12:15], s53 offen offset:0
    buffer_load_dwordx4 v[52:55], v1, s[12:15], s53 offen offset:1024
    buffer_load_dwordx4 v[56:59], v1, s[12:15], s53 offen offset:2048
    buffer_load_dwordx4 v[60:63], v1, s[12:15], s53 offen offset:3072
    v_mov_b32 v24, 0
    v_mov_b32 v25, 0
    s_waitcnt vmcnt(0)
    v_dot2c_f32_bf16 v24, s32, v32
    v_dot2c_f32_bf16 v25, v32, v32
    v_dot2c_f32_bf16 v24, s32, v33
    v_dot2c_f32_bf16 v25, v33, v33
    v_dot2c_f32_bf16 v24, s32, v34
    v_dot2c_f32_bf16 v25, v34, v34
    v_dot2c_f32_bf16 v24, s32, v35
    v_dot2c_f32_bf16 v25, v35, v35
    v_dot2c_f32_bf16 v24, s32, v36
    v_dot2c_f32_bf16 v25, v36, v36
    v_dot2c_f32_bf16 v24, s32, v37
    v_dot2c_f32_bf16 v25, v37, v37
    v_dot2c_f32_bf16 v24, s32, v38
    v_dot2c_f32_bf16 v25, v38, v38
    v_dot2c_f32_bf16 v24, s32, v39
    v_dot2c_f32_bf16 v25, v39, v39
    v_dot2c_f32_bf16 v24, s32, v40
    v_dot2c_f32_bf16 v25, v40, v40
    v_dot2c_f32_bf16 v24, s32, v41
    v_dot2c_f32_bf16 v25, v41, v41
    v_dot2c_f32_bf16 v24, s32, v42
    v_dot2c_f32_bf16 v25, v42, v42
    v_dot2c_f32_bf16 v24, s32, v43
    v_dot2c_f32_bf16 v25, v43, v43
    v_dot2c_f32_bf16 v24, s32, v44
    v_dot2c_f32_bf16 v25, v44, v44
    v_dot2c_f32_bf16 v24, s32, v45
    v_dot2c_f32_bf16 v25, v45, v45
    v_dot2c_f32_bf16 v24, s32, v46
    v_dot2c_f32_bf16 v25, v46, v46
    v_dot2c_f32_bf16 v24, s32, v47
    v_dot2c_f32_bf16 v25, v47, v47
    v_dot2c_f32_bf16 v24, s32, v48
    v_dot2c_f32_bf16 v25, v48, v48
    v_dot2c_f32_bf16 v24, s32, v49
    v_dot2c_f32_bf16 v25, v49, v49
    v_dot2c_f32_bf16 v24, s32, v50
    v_dot2c_f32_bf16 v25, v50, v50
    v_dot2c_f32_bf16 v24, s32, v51
    v_dot2c_f32_bf16 v25, v51, v51
    v_dot2c_f32_bf16 v24, s32, v52
    v_dot2c_f32_bf16 v25, v52, v52
    v_dot2c_f32_bf16 v24, s32, v53
    v_dot2c_f32_bf16 v25, v53, v53
    v_dot2c_f32_bf16 v24, s32, v54
    v_dot2c_f32_bf16 v25, v54, v54
    v_dot2c_f32_bf16 v24, s32, v55
    v_dot2c_f32_bf16 v25, v55, v55
    v_dot2c_f32_bf16 v24, s32, v56
    v_dot2c_f32_bf16 v25, v56, v56
    v_dot2c_f32_bf16 v24, s32, v57
    v_dot2c_f32_bf16 v25, v57, v57
    v_dot2c_f32_bf16 v24, s32, v58
    v_dot2c_f32_bf16 v25, v58, v58
    v_dot2c_f32_bf16 v24, s32, v59
    v_dot2c_f32_bf16 v25, v59, v59
    v_dot2c_f32_bf16 v24, s32, v60
    v_dot2c_f32_bf16 v25, v60, v60
    v_dot2c_f32_bf16 v24, s32, v61
    v_dot2c_f32_bf16 v25, v61, v61
    v_dot2c_f32_bf16 v24, s32, v62
    v_dot2c_f32_bf16 v25, v62, v62
    v_dot2c_f32_bf16 v24, s32, v63
    v_dot2c_f32_bf16 v25, v63, v63
    s_nop 2
    v_fmamk_f32 v26, v20, 0xc2800000, v24
    v_add_f32 v24, v24, v26
    v_fma_f32 v25, -v20, v24, v25
    v_add_f32 v22, v22, v26
    v_add_f32 v23, v23, v25
    s_add_u32 s35, s35, 0x4000
    s_and_b32 s42, s35, 0xc000
    s_cbranch_scc1 L_hs_blk
    s_nop 1
    v_add_f32_dpp v22, v22, v22 row_ror:8 row_mask:0xf bank_mask:0xf
    v_add_f32_dpp v23, v23, v23 row_ror:8 row_mask:0xf bank_mask:0xf
    s_nop 1
    v_add_f32_dpp v22, v22, v22 row_ror:4 row_mask:0xf bank_mask:0xf
    v_add_f32_dpp v23, v23, v23 row_ror:4 row_mask:0xf bank_mask:0xf
    s_nop 1
    v_add_f32_dpp v22, v22, v22 row_ror:2 row_mask:0xf bank_mask:0xf
    v_add_f32_dpp v23, v23, v23 row_ror:2 row_mask:0xf bank_mask:0xf
    s_nop 1
    v_add_f32_dpp v22, v22, v22 row_ror:1 row_mask:0xf bank_mask:0xf
    v_add_f32_dpp v23, v23, v23 row_ror:1 row_mask:0xf bank_mask:0xf
    s_nop 1
    v_add_f32_dpp v22, v22, v22 row_bcast:15 row_mask:0xa bank_mask:0xf
    v_add_f32_dpp v23, v23, v23 row_bcast:15 row_mask:0xa bank_mask:0xf
    s_nop 1
    v_add_f32_dpp v22, v22, v22 row_bcast:31 row_mask:0xc bank_mask:0xf
    v_add_f32_dpp v23, v23, v23 row_bcast:31 row_mask:0xc bank_mask:0xf
    v_mul_f32 v24, 0x38800000, v22
    v_fma_f32 v23, -v22, v24, v23
    v_add_f32 v22, v20, v24
    v_max_f32 v23, 0, v23
    s_nop 0
    v_readlane_b32 s80, v22, 63
    v_readlane_b32 s82, v23, 63
    s_nop 1
    s_branch L_hfin
L_pre0:
    v_lshlrev_b32 v4, 16, v16
    v_and_b32 v5, s25, v16
    v_sub_f32 v4, v4, v8
    v_sub_f32 v5, v5, v8
    v_cvt_pk_bf16_f32 v16, v4, v5
    v_lshlrev_b32 v4, 16, v17
    v_and_b32 v5, s25, v17
    v_sub_f32 v4, v4, v8
    v_sub_f32 v5, v5, v8
    v_cvt_pk_bf16_f32 v17, v4, v5
    v_lshlrev_b32 v4, 16, v18
    v_and_b32 v5, s25, v18
    v_sub_f32 v4, v4, v8
    v_sub_f32 v5, v5, v8
    v_cvt_pk_bf16_f32 v18, v4, v5
    v_lshlrev_b32 v4, 16, v19
    v_and_b32 v5, s25, v19
    v_sub_f32 v4, v4, v8
    v_sub_f32 v5, v5, v8
    v_cvt_pk_bf16_f32 v19, v4, v5
    v_lshlrev_b32 v4, 16, v20
    v_and_b32 v5, s25, v20
    v_sub_f32 v4, v4, v8
    v_sub_f32 v5, v5, v8
    v_cvt_pk_bf16_f32 v20, v4, v5
    v_lshlrev_b32 v4, 16, v21
    v_and_b32 v5, s25, v21
    v_sub_f32 v4, v4, v8
    v_sub_f32 v5, v5, v8
    v_cvt_pk_bf16_f32 v21, v4, v5
    v_lshlrev_b32 v4, 16, v22
    v_and_b32 v5, s25, v22
    v_sub_f32 v4, v4, v8
    v_sub_f32 v5, v5, v8
    v_cvt_pk_bf16_f32 v22, v4, v5
    v_lshlrev_b32 v4, 16, v23
    v_and_b32 v5, s25, v23
    v_sub_f32 v4, v4, v8
    v_sub_f32 v5, v5, v8
    v_cvt_pk_bf16_f32 v23, v4, v5
    v_lshlrev_b32 v4, 16, v24
    v_and_b32 v5, s25, v24
    v_sub_f32 v4, v4, v8
    v_sub_f32 v5, v5, v8
    v_cvt_pk_bf16_f32 v24, v4, v5
    v_lshlrev_b32 v4, 16, v25
    v_and_b32 v5, s25, v25
    v_sub_f32 v4, v4, v8
    v_sub_f32 v5, v5, v8
    v_cvt_pk_bf16_f32 v25, v4, v5
    v_lshlrev_b32 v4, 16, v26
    v_and_b32 v5, s25, v26
    v_sub_f32 v4, v4, v8
    v_sub_f32 v5, v5, v8
    v_cvt_pk_bf16_f32 v26, v4, v5
    v_lshlrev_b32 v4, 16, v27
    v_and_b32 v5, s25, v27
    v_sub_f32 v4, v4, v8
    v_sub_f32 v5, v5, v8
    v_cvt_pk_bf16_f32 v27, v4, v5
    v_lshlrev_b32 v4, 16, v28
    v_and_b32 v5, s25, v28
    v_sub_f32 v4, v4, v8
    v_sub_f32 v5, v5, v8
    v_cvt_pk_bf16_f32 v28, v4, v5
    v_lshlrev_b32 v4, 16, v29
    v_and_b32 v5, s25, v29
    v_sub_f32 v4, v4, v8
    v_sub_f32 v5, v5, v8
    v_cvt_pk_bf16_f32 v29, v4, v5
    v_lshlrev_b32 v4, 16, v30
    v_and_b32 v5, s25, v30
    v_sub_f32 v4, v4, v8
    v_sub_f32 v5, v5, v8
    v_cvt_pk_bf16_f32 v30, v4, v5
    v_lshlrev_b32 v4, 16, v31
    v_and_b32 v5, s25, v31
    v_sub_f32 v4, v4, v8
    v_sub_f32 v5, v5, v8
    v_cvt_pk_bf16_f32 v31, v4, v5
    v_mov_b32 v8, 0
    s_branch L_go0
L_pre1:
    v_lshlrev_b32 v4, 16, v32
    v_and_b32 v5, s25, v32
    v_sub_f32 v4, v4, v8
    v_sub_f32 v5, v5, v8
    v_cvt_pk_bf16_f32 v32, v4, v5
    v_lshlrev_b32 v4, 16, v33
    v_and_b32 v5, s25, v33
    v_sub_f32 v4, v4, v8
    v_sub_f32 v5, v5, v8
    v_cvt_pk_bf16_f32 v33, v4, v5
    v_lshlrev_b32 v4, 16, v34
    v_and_b32 v5, s25, v34
    v_sub_f32 v4, v4, v8
    v_sub_f32 v5, v5, v8
    v_cvt_pk_bf16_f32 v34, v4, v5
    v_lshlrev_b32 v4, 16, v35
    v_and_b32 v5, s25, v35
    v_sub_f32 v4, v4, v8
    v_sub_f32 v5, v5, v8
    v_cvt_pk_bf16_f32 v35, v4, v5
    v_lshlrev_b32 v4, 16, v36
    v_and_b32 v5, s25, v36
    v_sub_f32 v4, v4, v8
    v_sub_f32 v5, v5, v8
    v_cvt_pk_bf16_f32 v36, v4, v5
    v_lshlrev_b32 v4, 16, v37
    v_and_b32 v5, s25, v37
    v_sub_f32 v4, v4, v8
    v_sub_f32 v5, v5, v8
    v_cvt_pk_bf16_f32 v37, v4, v5
    v_lshlrev_b32 v4, 16, v38
    v_and_b32 v5, s25, v38
    v_sub_f32 v4, v4, v8
    v_sub_f32 v5, v5, v8
    v_cvt_pk_bf16_f32 v38, v4, v5
    v_lshlrev_b32 v4, 16, v39
    v_and_b32 v5, s25, v39
    v_sub_f32 v4, v4, v8
    v_sub_f32 v5, v5, v8
    v_cvt_pk_bf16_f32 v39, v4, v5
    v_lshlrev_b32 v4, 16, v40
    v_and_b32 v5, s25, v40
    v_sub_f32 v4, v4, v8
    v_sub_f32 v5, v5, v8
    v_cvt_pk_bf16_f32 v40, v4, v5
    v_lshlrev_b32 v4, 16, v41
    v_and_b32 v5, s25, v41
    v_sub_f32 v4, v4, v8
    v_sub_f32 v5, v5, v8
    v_cvt_pk_bf16_f32 v41, v4, v5
    v_lshlrev_b32 v4, 16, v42
    v_and_b32 v5, s25, v42
    v_sub_f32 v4, v4, v8
    v_sub_f32 v5, v5, v8
    v_cvt_pk_bf16_f32 v42, v4, v5
    v_lshlrev_b32 v4, 16, v43
    v_and_b32 v5, s25, v43
    v_sub_f32 v4, v4, v8
    v_sub_f32 v5, v5, v8
    v_cvt_pk_bf16_f32 v43, v4, v5
    v_lshlrev_b32 v4, 16, v44
    v_and_b32 v5, s25, v44
    v_sub_f32 v4, v4, v8
    v_sub_f32 v5, v5, v8
    v_cvt_pk_bf16_f32 v44, v4, v5
    v_lshlrev_b32 v4, 16, v45
    v_and_b32 v5, s25, v45
    v_sub_f32 v4, v4, v8
    v_sub_f32 v5, v5, v8
    v_cvt_pk_bf16_f32 v45, v4, v5
    v_lshlrev_b32 v4, 16, v46
    v_and_b32 v5, s25, v46
    v_sub_f32 v4, v4, v8
    v_sub_f32 v5, v5, v8
    v_cvt_pk_bf16_f32 v46, v4, v5
    v_lshlrev_b32 v4, 16, v47
    v_and_b32 v5, s25, v47
    v_sub_f32 v4, v4, v8
    v_sub_f32 v5, v5, v8
    v_cvt_pk_bf16_f32 v47, v4, v5
    v_mov_b32 v8, 0
    s_branch L_go1
L_pre2:
    v_lshlrev_b32 v4, 16, v48
    v_and_b32 v5, s25, v48
    v_sub_f32 v4, v4, v8
    v_sub_f32 v5, v5, v8
    v_cvt_pk_bf16_f32 v48, v4, v5
    v_lshlrev_b32 v4, 16, v49
    v_and_b32 v5, s25, v49
    v_sub_f32 v4, v4, v8
    v_sub_f32 v5, v5, v8
    v_cvt_pk_bf16_f32 v49, v4, v5
    v_lshlrev_b32 v4, 16, v50
    v_and_b32 v5, s25, v50
    v_sub_f32 v4, v4, v8
    v_sub_f32 v5, v5, v8
    v_cvt_pk_bf16_f32 v50, v4, v5
    v_lshlrev_b32 v4, 16, v51
    v_and_b32 v5, s25, v51
    v_sub_f32 v4, v4, v8
    v_sub_f32 v5, v5, v8
    v_cvt_pk_bf16_f32 v51, v4, v5
    v_lshlrev_b32 v4, 16, v52
    v_and_b32 v5, s25, v52
    v_sub_f32 v4, v4, v8
    v_sub_f32 v5, v5, v8
    v_cvt_pk_bf16_f32 v52, v4, v5
    v_lshlrev_b32 v4, 16, v53
    v_and_b32 v5, s25, v53
    v_sub_f32 v4, v4, v8
    v_sub_f32 v5, v5, v8
    v_cvt_pk_bf16_f32 v53, v4, v5
    v_lshlrev_b32 v4, 16, v54
    v_and_b32 v5, s25, v54
    v_sub_f32 v4, v4, v8
    v_sub_f32 v5, v5, v8
    v_cvt_pk_bf16_f32 v54, v4, v5
    v_lshlrev_b32 v4, 16, v55
    v_and_b32 v5, s25, v55
    v_sub_f32 v4, v4, v8
    v_sub_f32 v5, v5, v8
    v_cvt_pk_bf16_f32 v55, v4, v5
    v_lshlrev_b32 v4, 16, v56
    v_and_b32 v5, s25, v56
    v_sub_f32 v4, v4, v8
    v_sub_f32 v5, v5, v8
    v_cvt_pk_bf16_f32 v56, v4, v5
    v_lshlrev_b32 v4, 16, v57
    v_and_b32 v5, s25, v57
    v_sub_f32 v4, v4, v8
    v_sub_f32 v5, v5, v8
    v_cvt_pk_bf16_f32 v57, v4, v5
    v_lshlrev_b32 v4, 16, v58
    v_and_b32 v5, s25, v58
    v_sub_f32 v4, v4, v8
    v_sub_f32 v5, v5, v8
    v_cvt_pk_bf16_f32 v58, v4, v5
    v_lshlrev_b32 v4, 16, v59
    v_and_b32 v5, s25, v59
    v_sub_f32 v4, v4, v8
    v_sub_f32 v5, v5, v8
    v_cvt_pk_bf16_f32 v59, v4, v5
    v_lshlrev_b32 v4, 16, v60
    v_and_b32 v5, s25, v60
    v_sub_f32 v4, v4, v8
    v_sub_f32 v5, v5, v8
    v_cvt_pk_bf16_f32 v60, v4, v5
    v_lshlrev_b32 v4, 16, v61
    v_and_b32 v5, s25, v61
    v_sub_f32 v4, v4, v8
    v_sub_f32 v5, v5, v8
    v_cvt_pk_bf16_f32 v61, v4, v5
    v_lshlrev_b32 v4, 16, v62
    v_and_b32 v5, s25, v62
    v_sub_f32 v4, v4, v8
    v_sub_f32 v5, v5, v8
    v_cvt_pk_bf16_f32 v62, v4, v5
    v_lshlrev_b32 v4, 16, v63
    v_and_b32 v5, s25, v63
    v_sub_f32 v4, v4, v8
    v_sub_f32 v5, v5, v8
    v_cvt_pk_bf16_f32 v63, v4, v5
    v_mov_b32 v8, 0
    s_branch L_go2
L_pre3:
    v_lshlrev_b32 v4, 16, v64
    v_and_b32 v5, s25, v64
    v_sub_f32 v4, v4, v8
    v_sub_f32 v5, v5, v8
    v_cvt_pk_bf16_f32 v64, v4, v5
    v_lshlrev_b32 v4, 16, v65
    v_and_b32 v5, s25, v65
    v_sub_f32 v4, v4, v8
    v_sub_f32 v5, v5, v8
    v_cvt_pk_bf16_f32 v65, v4, v5
    v_lshlrev_b32 v4, 16, v66
    v_and_b32 v5, s25, v66
    v_sub_f32 v4, v4, v8
    v_sub_f32 v5, v5, v8
    v_cvt_pk_bf16_f32 v66, v4, v5
    v_lshlrev_b32 v4, 16, v67
    v_and_b32 v5, s25, v67
    v_sub_f32 v4, v4, v8
    v_sub_f32 v5, v5, v8
    v_cvt_pk_bf16_f32 v67, v4, v5
    v_lshlrev_b32 v4, 16, v68
    v_and_b32 v5, s25, v68
    v_sub_f32 v4, v4, v8
    v_sub_f32 v5, v5, v8
    v_cvt_pk_bf16_f32 v68, v4, v5
    v_lshlrev_b32 v4, 16, v69
    v_and_b32 v5, s25, v69
    v_sub_f32 v4, v4, v8
    v_sub_f32 v5, v5, v8
    v_cvt_pk_bf16_f32 v69, v4, v5
    v_lshlrev_b32 v4, 16, v70
    v_and_b32 v5, s25, v70
    v_sub_f32 v4, v4, v8
    v_sub_f32 v5, v5, v8
    v_cvt_pk_bf16_f32 v70, v4, v5
    v_lshlrev_b32 v4, 16, v71
    v_and_b32 v5, s25, v71
    v_sub_f32 v4, v4, v8
    v_sub_f32 v5, v5, v8
    v_cvt_pk_bf16_f32 v71, v4, v5
    v_lshlrev_b32 v4, 16, v72
    v_and_b32 v5, s25, v72
    v_sub_f32 v4, v4, v8
    v_sub_f32 v5, v5, v8
    v_cvt_pk_bf16_f32 v72, v4, v5
    v_lshlrev_b32 v4, 16, v73
    v_and_b32 v5, s25, v73
    v_sub_f32 v4, v4, v8
    v_sub_f32 v5, v5, v8
    v_cvt_pk_bf16_f32 v73, v4, v5
    v_lshlrev_b32 v4, 16, v74
    v_and_b32 v5, s25, v74
    v_sub_f32 v4, v4, v8
    v_sub_f32 v5, v5, v8
    v_cvt_pk_bf16_f32 v74, v4, v5
    v_lshlrev_b32 v4, 16, v75
    v_and_b32 v5, s25, v75
    v_sub_f32 v4, v4, v8
    v_sub_f32 v5, v5, v8
    v_cvt_pk_bf16_f32 v75, v4, v5
    v_lshlrev_b32 v4, 16, v76
    v_and_b32 v5, s25, v76
    v_sub_f32 v4, v4, v8
    v_sub_f32 v5, v5, v8
    v_cvt_pk_bf16_f32 v76, v4, v5
    v_lshlrev_b32 v4, 16, v77
    v_and_b32 v5, s25, v77
    v_sub_f32 v4, v4, v8
    v_sub_f32 v5, v5, v8
    v_cvt_pk_bf16_f32 v77, v4, v5
    v_lshlrev_b32 v4, 16, v78
    v_and_b32 v5, s25, v78
    v_sub_f32 v4, v4, v8
    v_sub_f32 v5, v5, v8
    v_cvt_pk_bf16_f32 v78, v4, v5
    v_lshlrev_b32 v4, 16, v79
    v_and_b32 v5, s25, v79
    v_sub_f32 v4, v4, v8
    v_sub_f32 v5, v5, v8
    v_cvt_pk_bf16_f32 v79, v4, v5
    v_mov_b32 v8, 0
    s_branch L_go3
L_pre5:
    v_lshlrev_b32 v4, 16, v96
    v_and_b32 v5, s25, v96
    v_sub_f32 v4, v4, v8
    v_sub_f32 v5, v5, v8
    v_cvt_pk_bf16_f32 v96, v4, v5
    v_lshlrev_b32 v4, 16, v97
    v_and_b32 v5, s25, v97
    v_sub_f32 v4, v4, v8
    v_sub_f32 v5, v5, v8
    v_cvt_pk_bf16_f32 v97, v4, v5
    v_lshlrev_b32 v4, 16, v98
    v_and_b32 v5, s25, v98
    v_sub_f32 v4, v4, v8
    v_sub_f32 v5, v5, v8
    v_cvt_pk_bf16_f32 v98, v4, v5
    v_lshlrev_b32 v4, 16, v99
    v_and_b32 v5, s25, v99
    v_sub_f32 v4, v4, v8
    v_sub_f32 v5, v5, v8
    v_cvt_pk_bf16_f32 v99, v4, v5
    v_lshlrev_b32 v4, 16, v100
    v_and_b32 v5, s25, v100
    v_sub_f32 v4, v4, v8
    v_sub_f32 v5, v5, v8
    v_cvt_pk_bf16_f32 v100, v4, v5
    v_lshlrev_b32 v4, 16, v101
    v_and_b32 v5, s25, v101
    v_sub_f32 v4, v4, v8
    v_sub_f32 v5, v5, v8
    v_cvt_pk_bf16_f32 v101, v4, v5
    v_lshlrev_b32 v4, 16, v102
    v_and_b32 v5, s25, v102
    v_sub_f32 v4, v4, v8
    v_sub_f32 v5, v5, v8
    v_cvt_pk_bf16_f32 v102, v4, v5
    v_lshlrev_b32 v4, 16, v103
    v_and_b32 v5, s25, v103
    v_sub_f32 v4, v4, v8
    v_sub_f32 v5, v5, v8
    v_cvt_pk_bf16_f32 v103, v4, v5
    v_lshlrev_b32 v4, 16, v104
    v_and_b32 v5, s25, v104
    v_sub_f32 v4, v4, v8
    v_sub_f32 v5, v5, v8
    v_cvt_pk_bf16_f32 v104, v4, v5
    v_lshlrev_b32 v4, 16, v105
    v_and_b32 v5, s25, v105
    v_sub_f32 v4, v4, v8
    v_sub_f32 v5, v5, v8
    v_cvt_pk_bf16_f32 v105, v4, v5
    v_lshlrev_b32 v4, 16, v106
    v_and_b32 v5, s25, v106
    v_sub_f32 v4, v4, v8
    v_sub_f32 v5, v5, v8
    v_cvt_pk_bf16_f32 v106, v4, v5
    v_lshlrev_b32 v4, 16, v107
    v_and_b32 v5, s25, v107
    v_sub_f32 v4, v4, v8
    v_sub_f32 v5, v5, v8
    v_cvt_pk_bf16_f32 v107, v4, v5
    v_lshlrev_b32 v4, 16, v108
    v_and_b32 v5, s25, v108
    v_sub_f32 v4, v4, v8
    v_sub_f32 v5, v5, v8
    v_cvt_pk_bf16_f32 v108, v4, v5
    v_lshlrev_b32 v4, 16, v109
    v_and_b32 v5, s25, v109
    v_sub_f32 v4, v4, v8
    v_sub_f32 v5, v5, v8
    v_cvt_pk_bf16_f32 v109, v4, v5
    v_lshlrev_b32 v4, 16, v110
    v_and_b32 v5, s25, v110
    v_sub_f32 v4, v4, v8
    v_sub_f32 v5, v5, v8
    v_cvt_pk_bf16_f32 v110, v4, v5
    v_lshlrev_b32 v4, 16, v111
    v_and_b32 v5, s25, v111
    v_sub_f32 v4, v4, v8
    v_sub_f32 v5, v5, v8
    v_cvt_pk_bf16_f32 v111, v4, v5
    v_mov_b32 v8, 0
    s_branch L_go5
L_pre4:
    v_lshlrev_b32 v4, 16, v80
    v_and_b32 v5, s25, v80
    v_sub_f32 v4, v4, v8
    v_sub_f32 v5, v5, v8
    v_cvt_pk_bf16_f32 v80, v4, v5
    v_lshlrev_b32 v4, 16, v81
    v_and_b32 v5, s25, v81
    v_sub_f32 v4, v4, v8
    v_sub_f32 v5, v5, v8
    v_cvt_pk_bf16_f32 v81, v4, v5
    v_lshlrev_b32 v4, 16, v82
    v_and_b32 v5, s25, v82
    v_sub_f32 v4, v4, v8
    v_sub_f32 v5, v5, v8
    v_cvt_pk_bf16_f32 v82, v4, v5
    v_lshlrev_b32 v4, 16, v83
    v_and_b32 v5, s25, v83
    v_sub_f32 v4, v4, v8
    v_sub_f32 v5, v5, v8
    v_cvt_pk_bf16_f32 v83, v4, v5
    v_lshlrev_b32 v4, 16, v84
    v_and_b32 v5, s25, v84
    v_sub_f32 v4, v4, v8
    v_sub_f32 v5, v5, v8
    v_cvt_pk_bf16_f32 v84, v4, v5
    v_lshlrev_b32 v4, 16, v85
    v_and_b32 v5, s25, v85
    v_sub_f32 v4, v4, v8
    v_sub_f32 v5, v5, v8
    v_cvt_pk_bf16_f32 v85, v4, v5
    v_lshlrev_b32 v4, 16, v86
    v_and_b32 v5, s25, v86
    v_sub_f32 v4, v4, v8
    v_sub_f32 v5, v5, v8
    v_cvt_pk_bf16_f32 v86, v4, v5
    v_lshlrev_b32 v4, 16, v87
    v_and_b32 v5, s25, v87
    v_sub_f32 v4, v4, v8
    v_sub_f32 v5, v5, v8
    v_cvt_pk_bf16_f32 v87, v4, v5
    v_lshlrev_b32 v4, 16, v88
    v_and_b32 v5, s25, v88
    v_sub_f32 v4, v4, v8
    v_sub_f32 v5, v5, v8
    v_cvt_pk_bf16_f32 v88, v4, v5
    v_lshlrev_b32 v4, 16, v89
    v_and_b32 v5, s25, v89
    v_sub_f32 v4, v4, v8
    v_sub_f32 v5, v5, v8
    v_cvt_pk_bf16_f32 v89, v4, v5
    v_lshlrev_b32 v4, 16, v90
    v_and_b32 v5, s25, v90
    v_sub_f32 v4, v4, v8
    v_sub_f32 v5, v5, v8
    v_cvt_pk_bf16_f32 v90, v4, v5
    v_lshlrev_b32 v4, 16, v91
    v_and_b32 v5, s25, v91
    v_sub_f32 v4, v4, v8
    v_sub_f32 v5, v5, v8
    v_cvt_pk_bf16_f32 v91, v4, v5
    v_lshlrev_b32 v4, 16, v92
    v_and_b32 v5, s25, v92
    v_sub_f32 v4, v4, v8
    v_sub_f32 v5, v5, v8
    v_cvt_pk_bf16_f32 v92, v4, v5
    v_lshlrev_b32 v4, 16, v93
    v_and_b32 v5, s25, v93
    v_sub_f32 v4, v4, v8
    v_sub_f32 v5, v5, v8
    v_cvt_pk_bf16_f32 v93, v4, v5
    v_lshlrev_b32 v4, 16, v94
    v_and_b32 v5, s25, v94
    v_sub_f32 v4, v4, v8
    v_sub_f32 v5, v5, v8
    v_cvt_pk_bf16_f32 v94, v4, v5
    v_lshlrev_b32 v4, 16, v95
    v_and_b32 v5, s25, v95
    v_sub_f32 v4, v4, v8
    v_sub_f32 v5, v5, v8
    v_cvt_pk_bf16_f32 v95, v4, v5
    v_mov_b32 v8, 0
    s_branch L_go4
L_pre6:
    v_lshlrev_b32 v4, 16, v112
    v_and_b32 v5, s25, v112
    v_sub_f32 v4, v4, v8
    v_sub_f32 v5, v5, v8
    v_cvt_pk_bf16_f32 v112, v4, v5
    v_lshlrev_b32 v4, 16, v113
    v_and_b32 v5, s25, v113
    v_sub_f32 v4, v4, v8
    v_sub_f32 v5, v5, v8
    v_cvt_pk_bf16_f32 v113, v4, v5
    v_lshlrev_b32 v4, 16, v114
    v_and_b32 v5, s25, v114
    v_sub_f32 v4, v4, v8
    v_sub_f32 v5, v5, v8
    v_cvt_pk_bf16_f32 v114, v4, v5
    v_lshlrev_b32 v4, 16, v115
    v_and_b32 v5, s25, v115
    v_sub_f32 v4, v4, v8
    v_sub_f32 v5, v5, v8
    v_cvt_pk_bf16_f32 v115, v4, v5
    v_lshlrev_b32 v4, 16, v116
    v_and_b32 v5, s25, v116
    v_sub_f32 v4, v4, v8
    v_sub_f32 v5, v5, v8
    v_cvt_pk_bf16_f32 v116, v4, v5
    v_lshlrev_b32 v4, 16, v117
    v_and_b32 v5, s25, v117
    v_sub_f32 v4, v4, v8
    v_sub_f32 v5, v5, v8
    v_cvt_pk_bf16_f32 v117, v4, v5
    v_lshlrev_b32 v4, 16, v118
    v_and_b32 v5, s25, v118
    v_sub_f32 v4, v4, v8
    v_sub_f32 v5, v5, v8
    v_cvt_pk_bf16_f32 v118, v4, v5
    v_lshlrev_b32 v4, 16, v119
    v_and_b32 v5, s25, v119
    v_sub_f32 v4, v4, v8
    v_sub_f32 v5, v5, v8
    v_cvt_pk_bf16_f32 v119, v4, v5
    v_lshlrev_b32 v4, 16, v120
    v_and_b32 v5, s25, v120
    v_sub_f32 v4, v4, v8
    v_sub_f32 v5, v5, v8
    v_cvt_pk_bf16_f32 v120, v4, v5
    v_lshlrev_b32 v4, 16, v121
    v_and_b32 v5, s25, v121
    v_sub_f32 v4, v4, v8
    v_sub_f32 v5, v5, v8
    v_cvt_pk_bf16_f32 v121, v4, v5
    v_lshlrev_b32 v4, 16, v122
    v_and_b32 v5, s25, v122
    v_sub_f32 v4, v4, v8
    v_sub_f32 v5, v5, v8
    v_cvt_pk_bf16_f32 v122, v4, v5
    v_lshlrev_b32 v4, 16, v123
    v_and_b32 v5, s25, v123
    v_sub_f32 v4, v4, v8
    v_sub_f32 v5, v5, v8
    v_cvt_pk_bf16_f32 v123, v4, v5
    v_lshlrev_b32 v4, 16, v124
    v_and_b32 v5, s25, v124
    v_sub_f32 v4, v4, v8
    v_sub_f32 v5, v5, v8
    v_cvt_pk_bf16_f32 v124, v4, v5
    v_lshlrev_b32 v4, 16, v125
    v_and_b32 v5, s25, v125
    v_sub_f32 v4, v4, v8
    v_sub_f32 v5, v5, v8
    v_cvt_pk_bf16_f32 v125, v4, v5
    v_lshlrev_b32 v4, 16, v126
    v_and_b32 v5, s25, v126
    v_sub_f32 v4, v4, v8
    v_sub_f32 v5, v5, v8
    v_cvt_pk_bf16_f32 v126, v4, v5
    v_lshlrev_b32 v4, 16, v127
    v_and_b32 v5, s25, v127
    v_sub_f32 v4, v4, v8
    v_sub_f32 v5, v5, v8
    v_cvt_pk_bf16_f32 v127, v4, v5
    v_mov_b32 v8, 0
    s_branch L_go6
L_pre7:
    v_lshlrev_b32 v4, 16, v128
    v_and_b32 v5, s25, v128
    v_sub_f32 v4, v4, v8
    v_sub_f32 v5, v5, v8
    v_cvt_pk_bf16_f32 v128, v4, v5
    v_lshlrev_b32 v4, 16, v129
    v_and_b32 v5, s25, v129
    v_sub_f32 v4, v4, v8
    v_sub_f32 v5, v5, v8
    v_cvt_pk_bf16_f32 v129, v4, v5
    v_lshlrev_b32 v4, 16, v130
    v_and_b32 v5, s25, v130
    v_sub_f32 v4, v4, v8
    v_sub_f32 v5, v5, v8
    v_cvt_pk_bf16_f32 v130, v4, v5
    v_lshlrev_b32 v4, 16, v131
    v_and_b32 v5, s25, v131
    v_sub_f32 v4, v4, v8
    v_sub_f32 v5, v5, v8
    v_cvt_pk_bf16_f32 v131, v4, v5
    v_lshlrev_b32 v4, 16, v132
    v_and_b32 v5, s25, v132
    v_sub_f32 v4, v4, v8
    v_sub_f32 v5, v5, v8
    v_cvt_pk_bf16_f32 v132, v4, v5
    v_lshlrev_b32 v4, 16, v133
    v_and_b32 v5, s25, v133
    v_sub_f32 v4, v4, v8
    v_sub_f32 v5, v5, v8
    v_cvt_pk_bf16_f32 v133, v4, v5
    v_lshlrev_b32 v4, 16, v134
    v_and_b32 v5, s25, v134
    v_sub_f32 v4, v4, v8
    v_sub_f32 v5, v5, v8
    v_cvt_pk_bf16_f32 v134, v4, v5
    v_lshlrev_b32 v4, 16, v135
    v_and_b32 v5, s25, v135
    v_sub_f32 v4, v4, v8
    v_sub_f32 v5, v5, v8
    v_cvt_pk_bf16_f32 v135, v4, v5
    v_lshlrev_b32 v4, 16, v136
    v_and_b32 v5, s25, v136
    v_sub_f32 v4, v4, v8
    v_sub_f32 v5, v5, v8
    v_cvt_pk_bf16_f32 v136, v4, v5
    v_lshlrev_b32 v4, 16, v137
    v_and_b32 v5, s25, v137
    v_sub_f32 v4, v4, v8
    v_sub_f32 v5, v5, v8
    v_cvt_pk_bf16_f32 v137, v4, v5
    v_lshlrev_b32 v4, 16, v138
    v_and_b32 v5, s25, v138
    v_sub_f32 v4, v4, v8
    v_sub_f32 v5, v5, v8
    v_cvt_pk_bf16_f32 v138, v4, v5
    v_lshlrev_b32 v4, 16, v139
    v_and_b32 v5, s25, v139
    v_sub_f32 v4, v4, v8
    v_sub_f32 v5, v5, v8
    v_cvt_pk_bf16_f32 v139, v4, v5
    v_lshlrev_b32 v4, 16, v140
    v_and_b32 v5, s25, v140
    v_sub_f32 v4, v4, v8
    v_sub_f32 v5, v5, v8
    v_cvt_pk_bf16_f32 v140, v4, v5
    v_lshlrev_b32 v4, 16, v141
    v_and_b32 v5, s25, v141
    v_sub_f32 v4, v4, v8
    v_sub_f32 v5, v5, v8
    v_cvt_pk_bf16_f32 v141, v4, v5
    v_lshlrev_b32 v4, 16, v142
    v_and_b32 v5, s25, v142
    v_sub_f32 v4, v4, v8
    v_sub_f32 v5, v5, v8
    v_cvt_pk_bf16_f32 v142, v4, v5
    v_lshlrev_b32 v4, 16, v143
    v_and_b32 v5, s25, v143
    v_sub_f32 v4, v4, v8
    v_sub_f32 v5, v5, v8
    v_cvt_pk_bf16_f32 v143, v4, v5
    v_mov_b32 v8, 0
    s_branch L_go7
    .fill 64, 4, 0xbf810000
.section .rodata,"a"
.p2align 6
.amdhsa_kernel standalone__groupnorm__sampling_kernel
  .amdhsa_next_free_vgpr 144
  .amdhsa_next_free_sgpr 100
  .amdhsa_accum_offset 144
  .amdhsa_group_segment_fixed_size 0
  .amdhsa_kernarg_size 48
  .amdhsa_user_sgpr_count 2
  .amdhsa_user_sgpr_kernarg_segment_ptr 1
  .amdhsa_system_sgpr_workgroup_id_x 1
  .amdhsa_float_denorm_mode_32 3
.end_amdhsa_kernel
```
